```python
import torch

def _softmax(x, axis=-1):
    return torch.softmax(x, dim=axis)
def _gelu(x):
    return torch.nn.functional.gelu(x, approximate="tanh")
def _silu(x):
    return torch.nn.functional.silu(x)
def _sigmoid(x):
    return torch.sigmoid(x)
def _layernorm(x, axis=-1, eps=1e-5):
    m = x.mean(dim=axis, keepdim=True)
    v = x.var(dim=axis, keepdim=True, unbiased=False)
    return (x - m) / torch.sqrt(v + eps)
def _scatter_add(tgt, idx, src, axis=0):
    return tgt.clone().index_add_(axis, idx, src)
def _segment_sum(src, seg, n):
    out = torch.zeros((n,) + src.shape[1:], dtype=src.dtype)
    return out.index_add_(0, seg, src)
def _pad(x, pw):
    flat = tuple(v for pair in reversed(pw) for v in pair)
    return torch.nn.functional.pad(x, flat)

kernel_name = 'standalone__gqa_block_cached__near_ridge'

def setup_inputs():

    _w = (lambda a: (lambda t: t.to(torch.bfloat16) if t.is_floating_point() else t)(torch.as_tensor(a)))
    B, Sq, D = 16, 32, 640
    Hq, Hkv, Sk, Dh = 32, 32, 32, 192
    assert Hq % Hkv == 0, (Hq, Hkv)
    return {
        "x": _w((lambda *s: torch.randn(*s, dtype=torch.bfloat16) * 0.8)(B, Sq, D)),
        "k_cache": _w((lambda *s: torch.randn(*s, dtype=torch.bfloat16) * 0.8)(B, Hkv, Sk, Dh)),
        "v_cache": _w((lambda *s: torch.randn(*s, dtype=torch.bfloat16) * 0.05)(B, Hkv, Sk, Dh)),
        "wq": _w((lambda *s: torch.randn(*s, dtype=torch.bfloat16) * 0.8)(D, Hq * Dh) * (D ** -0.5)),
        "wo": _w((lambda *s: torch.randn(*s, dtype=torch.bfloat16) * 0.05)(Hq * Dh, D) * ((Hq * Dh) ** -0.5)),
    }

def reference(x, k_cache, v_cache, wq, wo):
    B, Sq, D = x.shape
    Hq, Dh = 32, 192
    Hkv = k_cache.shape[1]
    rep = Hq // Hkv
    q = (lambda x, *d: x.permute(*d))((x @ wq).reshape(B, Sq, Hq, Dh), 0, 2, 1, 3)
    k = (lambda x, n, axis: torch.repeat_interleave(x, n, dim=axis))(k_cache, rep, axis=1)
    v = (lambda x, n, axis: torch.repeat_interleave(x, n, dim=axis))(v_cache, rep, axis=1)
    scores = torch.einsum("bhqd,bhkd->bhqk", q, k) * (Dh ** -0.5)
    p = _softmax(scores, axis=-1)
    o = torch.einsum("bhqk,bhkd->bhqd", p, v)
    return (lambda x, *d: x.permute(*d))(o, 0, 2, 1, 3).reshape(B, Sq, Hq * Dh) @ wo
```

```asm
; @launch grid=(256,1,1) block=(256,1,1) lds=163840
.amdgcn_target "amdgcn-amd-amdhsa--gfx950"
.text
.globl standalone__gqa_block_cached__near_ridge_kernel
.p2align 8
.type standalone__gqa_block_cached__near_ridge_kernel,@function
standalone__gqa_block_cached__near_ridge_kernel:
    s_cmp_ge_u32 s2, 256
    s_cbranch_scc1 L_end
    s_load_dwordx2 s[32:33], s[0:1], 0
    s_load_dwordx2 s[44:45], s[0:1], 24
    s_load_dwordx2 s[40:41], s[0:1], 16
    s_load_dwordx2 s[48:49], s[0:1], 32
    s_getpc_b64 s[66:67]
L_pc:
    v_lshrrev_b32 v2, 6, v0
    v_and_b32 v3, 63, v0
    s_lshr_b32 s13, s2, 3
    s_mul_i32 s13, s13, 12
    v_mul_u32_u24 v2, 3, v2
    v_add3_u32 v2, v2, v3, s13
    v_lshlrev_b32 v2, 7, v2
    v_min_u32 v2, L_end-L_pc, v2
    s_mov_b64 exec, 7
    global_load_dword a254, v2, s[66:67]
    s_mov_b64 exec, -1
    v_lshrrev_b32 v2, 6, v0
    v_and_b32 v1, 63, v0
    v_readfirstlane_b32 s3, v2
    s_and_b32 s4, s2, 7
    s_lshr_b32 s5, s2, 3
    s_and_b32 s6, s5, 3
    s_bfe_u32 s7, s5, 0x20002
    s_add_u32 s19, s7, s6
    v_lshlrev_b32 v24, 4, v1
    v_lshrrev_b32 v25, 3, v1
    v_xor_b32 v26, v24, v1
    v_and_b32 v26, 0x70, v26
    v_xor_b32 v27, 64, v26
    s_lshl_b32 s8, s3, 14
    s_add_u32 s8, s8, 98304
    s_lshl_b32 s14, s7, 2
    s_add_u32 s14, s14, s3
    s_lshl_b32 s13, s4, 2
    s_cmp_ge_u32 s5, 16
    s_cbranch_scc1 L_roleB
    s_add_u32 s13, s13, s6
    v_mul_u32_u24 v11, 1280, v25
    v_add_u32 v8, v11, v26
    v_add_u32 v9, v11, v27
    v_add_u32 v10, 18432, v8
    v_add_u32 v11, 27648, v9
    v_add_u32 v9, 9216, v9
    s_mul_i32 s10, s14, 40960
    s_lshl_b32 s11, s14, 5
    s_add_u32 s11, s11, s13
    s_mul_i32 s9, s13, 384
    s_mul_i32 s12, s3, 6144
    s_and_b32 s18, s19, 1
    s_lshl_b32 s18, s18, 1
    s_xor_b32 s15, s18, s3
    s_lshl_b32 s18, s18, 5
    s_mul_i32 s15, s15, 196608
    s_bfe_u32 s14, s19, 0x10001
    s_add_u32 s9, s9, s15
    s_mul_i32 s24, s14, 786432
    s_add_u32 s24, s24, s9
    s_lshl_b32 s30, s14, 7
    s_add_u32 s30, s30, s10
    v_mul_u32_u24 v27, 2731, v1
    v_lshrrev_b32 v26, 16, v27
    v_mul_u32_u24 v26, 11904, v26
    v_lshrrev_b32 v25, 12, v27
    v_and_b32 v25, 32, v25
    v_add_u32 v26, v26, v24
    v_xor_b32 v2, v25, v26
    v_add_u32 v27, 174784, v27
    v_lshrrev_b32 v26, 16, v27
    v_mul_u32_u24 v26, 11904, v26
    v_lshrrev_b32 v25, 12, v27
    v_and_b32 v25, 32, v25
    v_add_u32 v26, v26, v24
    v_xor_b32 v3, v25, v26
    v_add_u32 v27, 174784, v27
    v_lshrrev_b32 v26, 16, v27
    v_mul_u32_u24 v26, 11904, v26
    v_lshrrev_b32 v25, 12, v27
    v_and_b32 v25, 32, v25
    v_add_u32 v26, v26, v24
    v_xor_b32 v4, v25, v26
    v_xor_b32 v5, 64, v2
    v_add_u32 v5, 98304, v5
    v_xor_b32 v6, 64, v3
    v_add_u32 v6, 98304, v6
    v_xor_b32 v7, 64, v4
    v_add_u32 v7, 98304, v7
    s_mov_b32 s34, 655360
    s_mov_b32 s35, 0x20000
    s_mov_b32 s46, 7864320
    s_mov_b32 s47, 0x20000
    s_waitcnt lgkmcnt(0)
    s_add_u32 m0, s8, 0
    s_nop 0
    buffer_load_dwordx4 v8, s[32:35], s30 offen offset:0  lds
    buffer_load_dwordx4 v9, s[32:35], s30 offen offset:1024  lds
    buffer_load_dwordx4 v10, s[32:35], s30 offen offset:2048  lds
    buffer_load_dwordx4 v11, s[32:35], s30 offen offset:3072  lds
    s_cmp_ge_u32 s3, 2
    s_cbranch_scc1 L_st1A
    s_add_u32 m0, s12, 0
    s_nop 0
    buffer_load_dwordx4 v2, s[44:47], s24 offen offset:0  lds
    buffer_load_dwordx4 v3, s[44:47], s24 offen offset:1024  lds
    buffer_load_dwordx4 v4, s[44:47], s24 offen offset:2048  lds
    s_add_u32 m0, s12, 3072
    s_nop 0
    buffer_load_dwordx4 v5, s[44:47], s24 offen offset:0  lds
    buffer_load_dwordx4 v6, s[44:47], s24 offen offset:1024  lds
    buffer_load_dwordx4 v7, s[44:47], s24 offen offset:2048  lds
    s_branch L_st1A
L_roleB:
    v_mul_u32_u24 v11, 384, v25
    v_add_u32 v8, v11, v26
    v_add_u32 v9, v11, v27
    v_add_u32 v10, 4096, v8
    v_add_u32 v11, 6144, v9
    v_add_u32 v9, 2048, v9
    s_lshl_b32 s10, s14, 5
    s_add_u32 s10, s10, s13
    s_mul_i32 s10, s10, 12288
    s_mul_i32 s9, s13, 245760
    s_mul_i32 s15, s3, 20480
    s_add_u32 s9, s9, s15
    s_mul_i32 s15, s6, 320
    s_add_u32 s9, s9, s15
    s_mul_i32 s12, s3, 5120
    s_add_u32 s14, s19, 0
    s_mul_i32 s15, s14, 86
    s_lshr_b32 s15, s15, 8
    s_mul_i32 s15, s15, 3
    s_sub_u32 s14, s14, s15
    s_mul_i32 s20, s14, 81920
    s_add_u32 s20, s20, s9
    s_lshl_b32 s26, s14, 7
    s_add_u32 s26, s26, s10
    v_mul_u32_u24 v27, 3277, v1
    v_lshrrev_b32 v26, 16, v27
    v_mul_u32_u24 v26, 960, v26
    v_add_u32 v2, v26, v24
    v_add_u32 v27, 209728, v27
    v_lshrrev_b32 v26, 16, v27
    v_mul_u32_u24 v26, 960, v26
    v_add_u32 v3, v26, v24
    v_add_u32 v27, 209728, v27
    v_lshrrev_b32 v26, 16, v27
    v_mul_u32_u24 v26, 960, v26
    v_add_u32 v4, v26, v24
    v_lshrrev_b32 v25, 1, v1
    v_and_b32 v25, 16, v25
    v_xor_b32 v4, v25, v4
    v_add_u32 v27, 209728, v27
    v_lshrrev_b32 v26, 16, v27
    v_mul_u32_u24 v26, 960, v26
    v_add_u32 v5, v26, v24
    v_xor_b32 v5, 16, v5
    v_add_u32 v5, 3072, v5
    v_add_u32 v27, 209728, v27
    v_lshrrev_b32 v26, 16, v27
    v_mul_u32_u24 v26, 960, v26
    v_add_u32 v6, v26, v24
    v_xor_b32 v6, 16, v6
    v_add_u32 v6, 3072, v6
    s_mov_b32 s42, 6291456
    s_mov_b32 s43, 0x20000
    s_mov_b32 s50, 7864320
    s_mov_b32 s51, 0x20000
    s_waitcnt lgkmcnt(0)
    s_add_u32 m0, s8, 0
    s_nop 0
    buffer_load_dwordx4 v8, s[40:43], s26 offen offset:0  lds
    buffer_load_dwordx4 v9, s[40:43], s26 offen offset:1024  lds
    buffer_load_dwordx4 v10, s[40:43], s26 offen offset:2048  lds
    buffer_load_dwordx4 v11, s[40:43], s26 offen offset:3072  lds
    s_cmp_ge_u32 s3, 2
    s_cbranch_scc1 L_st1B
    s_add_u32 m0, s12, 0
    s_nop 0
    buffer_load_dwordx4 v2, s[48:51], s20 offen offset:0  lds
    buffer_load_dwordx4 v3, s[48:51], s20 offen offset:1024  lds
    buffer_load_dwordx4 v4, s[48:51], s20 offen offset:2048  lds
    s_add_u32 m0, s12, 3072
    s_nop 0
    buffer_load_dwordx4 v5, s[48:51], s20 offen offset:0  lds
    buffer_load_dwordx4 v6, s[48:51], s20 offen offset:1024  lds
    s_branch L_st1B
L_st1A:
    s_load_dwordx2 s[36:37], s[0:1], 8
    s_load_dwordx2 s[56:57], s[0:1], 56
    s_load_dwordx2 s[60:61], s[0:1], 48
    s_load_dwordx2 s[52:53], s[0:1], 40
    s_add_u32 s14, s19, 0
    s_and_b32 s14, s14, 3
    s_mul_i32 s20, s14, 786432
    s_add_u32 s20, s20, s9
    s_lshl_b32 s26, s14, 7
    s_add_u32 s26, s26, s10
    s_add_u32 s14, s19, 1
    s_and_b32 s14, s14, 3
    s_mul_i32 s21, s14, 786432
    s_add_u32 s21, s21, s9
    s_lshl_b32 s27, s14, 7
    s_add_u32 s27, s27, s10
    s_add_u32 s14, s19, 2
    s_and_b32 s14, s14, 3
    s_mul_i32 s22, s14, 786432
    s_add_u32 s22, s22, s9
    s_lshl_b32 s28, s14, 7
    s_add_u32 s28, s28, s10
    s_add_u32 s14, s19, 3
    s_and_b32 s14, s14, 3
    s_mul_i32 s23, s14, 786432
    s_add_u32 s23, s23, s9
    s_lshl_b32 s29, s14, 7
    s_add_u32 s29, s29, s10
    s_bfe_u32 s14, s19, 0x10001
    s_xor_b32 s14, s14, 1
    s_mul_i32 s25, s14, 786432
    s_add_u32 s25, s25, s9
    s_lshl_b32 s31, s14, 7
    s_add_u32 s31, s31, s10
    v_and_b32 v25, 15, v1
    v_lshrrev_b32 v26, 1, v25
    v_lshrrev_b32 v27, 4, v1
    v_xor_b32 v26, v26, v27
    v_lshlrev_b32 v26, 4, v26
    v_lshl_add_u32 v25, v25, 7, v26
    v_add_u32 v16, s8, v25
    v_xor_b32 v16, s18, v16
    v_xor_b32 v17, 64, v16
    v_bfe_u32 v25, v1, 2, 2
    v_lshl_add_u32 v25, v27, 3, v25
    v_mul_u32_u24 v25, 384, v25
    v_and_b32 v26, 3, v1
    v_lshl_add_u32 v25, v26, 3, v25
    v_and_b32 v26, 0x18, v1
    v_lshl_add_u32 v18, v26, 2, v25
    v_xor_b32 v19, 32, v18
    v_xor_b32 v20, 64, v18
    v_xor_b32 v21, 96, v18
    v_add_u32 v22, 49152, v18
    v_add_u32 v23, 49152, v19
    v_add_u32 v30, 49152, v20
    v_add_u32 v31, 49152, v21
    s_cmp_lt_u32 s3, 2
    s_cbranch_scc1 L_st2A
    s_add_u32 m0, s12, 0
    s_nop 0
    buffer_load_dwordx4 v2, s[44:47], s24 offen offset:0  lds
    buffer_load_dwordx4 v3, s[44:47], s24 offen offset:1024  lds
    buffer_load_dwordx4 v4, s[44:47], s24 offen offset:2048  lds
    s_add_u32 m0, s12, 3072
    s_nop 0
    buffer_load_dwordx4 v5, s[44:47], s24 offen offset:0  lds
    buffer_load_dwordx4 v6, s[44:47], s24 offen offset:1024  lds
    buffer_load_dwordx4 v7, s[44:47], s24 offen offset:2048  lds
L_st2A:
    s_add_u32 m0, s8, 8192
    s_add_u32 s64, s26, 256
    buffer_load_dwordx4 v8, s[32:35], s64 offen offset:0  lds
    buffer_load_dwordx4 v9, s[32:35], s64 offen offset:1024  lds
    buffer_load_dwordx4 v10, s[32:35], s64 offen offset:2048  lds
    buffer_load_dwordx4 v11, s[32:35], s64 offen offset:3072  lds
    v_mov_b32 v0, 0
    s_mov_b32 s38, 6291456
    s_mov_b32 s39, 0x20000
    s_mov_b32 s58, 268435456
    s_mov_b32 s59, 0x20000
    s_mov_b32 s62, 256
    s_mov_b32 s63, 0x20000
    s_mov_b32 s54, 655360
    s_mov_b32 s55, 0x20000
    s_mul_i32 s11, s11, 12288
    s_waitcnt lgkmcnt(0)
    s_mov_b32 s48, s2
    s_mov_b32 s13, 2097164
    s_or_b32 s14, s2, s3
    s_cmp_lg_u32 s14, 0
    s_cbranch_scc1 L_npre
    s_load_dword s49, s[56:57], s13
    s_memrealtime s[16:17]
L_npre:
    s_lshl_b32 s13, s7, 2
    s_add_u32 s13, s13, s3
    s_lshl_b32 s13, s13, 5
    s_lshl_b32 s14, s4, 2
    s_add_u32 s13, s13, s14
    s_add_u32 s13, s13, s6
    s_mul_i32 s13, s13, 3072
    s_mov_b32 s40, s13
    s_add_u32 s51, s13, 12582912
    v_lshrrev_b32 v25, 3, v1
    v_xor_b32 v26, v24, v1
    v_and_b32 v26, 0x70, v26
    v_xor_b32 v27, 64, v26
    v_mul_u32_u24 v15, 384, v25
    v_add_u32 v12, v15, v26
    v_add_u32 v13, v15, v27
    v_add_u32 v14, 4096, v12
    v_add_u32 v15, 6144, v13
    v_add_u32 v13, 2048, v13
    v_and_b32 v25, 15, v1
    v_lshrrev_b32 v26, 1, v25
    v_lshrrev_b32 v27, 5, v1
    v_xor_b32 v26, v26, v27
    v_lshlrev_b32 v26, 4, v26
    v_lshl_add_u32 v25, v25, 7, v26
    v_and_b32 v26, 16, v1
    v_lshrrev_b32 v26, 1, v26
    v_add3_u32 v160, v25, v26, s8
    v_xor_b32 v161, 32, v160
    v_xor_b32 v162, 64, v160
    v_xor_b32 v163, 96, v160
    s_cmp_ge_u32 s3, 2
    s_cbranch_scc1 L_st3A
    s_waitcnt vmcnt(4)
L_st3A:
    s_waitcnt vmcnt(10)
    s_barrier
    ds_read_b128 a[64:67], v16 offset:0
    ds_read_b128 a[68:71], v16 offset:2048
    ds_read_b128 a[72:75], v17 offset:0
    ds_read_b128 a[76:79], v17 offset:2048
    ds_read_b64_tr_b16 a[0:1], v18 offset:0
    ds_read_b64_tr_b16 a[2:3], v18 offset:1536
    ds_read_b64_tr_b16 a[4:5], v19 offset:0
    ds_read_b64_tr_b16 a[6:7], v19 offset:1536
    ds_read_b64_tr_b16 a[8:9], v20 offset:0
    ds_read_b64_tr_b16 a[10:11], v20 offset:1536
    ds_read_b64_tr_b16 a[12:13], v21 offset:0
    ds_read_b64_tr_b16 a[14:15], v21 offset:1536
    ds_read_b64_tr_b16 a[16:17], v18 offset:128
    ds_read_b64_tr_b16 a[18:19], v18 offset:1664
    ds_read_b64_tr_b16 a[20:21], v19 offset:128
    ds_read_b64_tr_b16 a[22:23], v19 offset:1664
    s_waitcnt lgkmcnt(10)
    v_mfma_f32_16x16x32_bf16 v[64:67], a[0:3], a[64:67], 0
    s_waitcnt lgkmcnt(8)
    ds_read_b64_tr_b16 a[24:25], v20 offset:128
    ds_read_b64_tr_b16 a[26:27], v20 offset:1664
    v_mfma_f32_16x16x32_bf16 v[72:75], a[0:3], a[68:71], 0
    s_add_u32 m0, s8, 4096
    s_nop 0
    buffer_load_dwordx4 v8, s[32:35], s31 offen offset:0  lds
    v_mfma_f32_16x16x32_bf16 v[68:71], a[4:7], a[64:67], 0
    s_waitcnt lgkmcnt(8)
    ds_read_b64_tr_b16 a[28:29], v21 offset:128
    ds_read_b64_tr_b16 a[30:31], v21 offset:1664
    v_mfma_f32_16x16x32_bf16 v[76:79], a[4:7], a[68:71], 0
    buffer_load_dwordx4 v9, s[32:35], s31 offen offset:1024  lds
    buffer_load_dwordx4 v10, s[32:35], s31 offen offset:2048  lds
    v_mfma_f32_16x16x32_bf16 v[80:83], a[8:11], a[64:67], 0
    s_waitcnt lgkmcnt(8)
    ds_read_b64_tr_b16 a[32:33], v18 offset:256
    ds_read_b64_tr_b16 a[34:35], v18 offset:1792
    v_mfma_f32_16x16x32_bf16 v[88:91], a[8:11], a[68:71], 0
    buffer_load_dwordx4 v11, s[32:35], s31 offen offset:3072  lds
    s_add_u32 m0, s12, 24576
    s_nop 0
    buffer_load_dwordx4 v2, s[44:47], s25 offen offset:0  lds
    v_mfma_f32_16x16x32_bf16 v[84:87], a[12:15], a[64:67], 0
    s_waitcnt lgkmcnt(8)
    ds_read_b64_tr_b16 a[36:37], v19 offset:256
    ds_read_b64_tr_b16 a[38:39], v19 offset:1792
    v_mfma_f32_16x16x32_bf16 v[92:95], a[12:15], a[68:71], 0
    buffer_load_dwordx4 v3, s[44:47], s25 offen offset:1024  lds
    v_mfma_f32_16x16x32_bf16 v[96:99], a[16:19], a[64:67], 0
    s_waitcnt lgkmcnt(8)
    ds_read_b64_tr_b16 a[40:41], v20 offset:256
    ds_read_b64_tr_b16 a[42:43], v20 offset:1792
    v_mfma_f32_16x16x32_bf16 v[104:107], a[16:19], a[68:71], 0
    buffer_load_dwordx4 v4, s[44:47], s25 offen offset:2048  lds
    s_add_u32 m0, s12, 27648
    s_nop 0
    buffer_load_dwordx4 v5, s[44:47], s25 offen offset:0  lds
    v_mfma_f32_16x16x32_bf16 v[100:103], a[20:23], a[64:67], 0
    s_waitcnt lgkmcnt(8)
    ds_read_b64_tr_b16 a[44:45], v21 offset:256
    ds_read_b64_tr_b16 a[46:47], v21 offset:1792
    v_mfma_f32_16x16x32_bf16 v[108:111], a[20:23], a[68:71], 0
    buffer_load_dwordx4 v6, s[44:47], s25 offen offset:1024  lds
    buffer_load_dwordx4 v7, s[44:47], s25 offen offset:2048  lds
    v_mfma_f32_16x16x32_bf16 v[112:115], a[24:27], a[64:67], 0
    s_waitcnt vmcnt(14)
    s_barrier
    s_waitcnt lgkmcnt(8)
    ds_read_b64_tr_b16 a[0:1], v18 offset:12288
    ds_read_b64_tr_b16 a[2:3], v18 offset:13824
    v_mfma_f32_16x16x32_bf16 v[120:123], a[24:27], a[68:71], 0
    v_mfma_f32_16x16x32_bf16 v[116:119], a[28:31], a[64:67], 0
    s_waitcnt lgkmcnt(8)
    ds_read_b64_tr_b16 a[4:5], v19 offset:12288
    ds_read_b64_tr_b16 a[6:7], v19 offset:13824
    v_mfma_f32_16x16x32_bf16 v[124:127], a[28:31], a[68:71], 0
    s_add_u32 m0, s12, 49152
    s_add_u32 s65, s20, 1572864
    buffer_load_dwordx4 v2, s[44:47], s65 offen offset:0  lds
    v_mfma_f32_16x16x32_bf16 v[128:131], a[32:35], a[64:67], 0
    s_waitcnt lgkmcnt(8)
    ds_read_b64_tr_b16 a[8:9], v20 offset:12288
    ds_read_b64_tr_b16 a[10:11], v20 offset:13824
    v_mfma_f32_16x16x32_bf16 v[136:139], a[32:35], a[68:71], 0
    buffer_load_dwordx4 v3, s[44:47], s65 offen offset:1024  lds
    v_mfma_f32_16x16x32_bf16 v[132:135], a[36:39], a[64:67], 0
    s_waitcnt lgkmcnt(8)
    ds_read_b64_tr_b16 a[12:13], v21 offset:12288
    ds_read_b64_tr_b16 a[14:15], v21 offset:13824
    v_mfma_f32_16x16x32_bf16 v[140:143], a[36:39], a[68:71], 0
    buffer_load_dwordx4 v4, s[44:47], s65 offen offset:2048  lds
    v_mfma_f32_16x16x32_bf16 v[144:147], a[40:43], a[64:67], 0
    s_waitcnt lgkmcnt(8)
    ds_read_b64_tr_b16 a[16:17], v18 offset:12416
    ds_read_b64_tr_b16 a[18:19], v18 offset:13952
    v_mfma_f32_16x16x32_bf16 v[152:155], a[40:43], a[68:71], 0
    s_add_u32 m0, s12, 52224
    s_nop 0
    buffer_load_dwordx4 v5, s[44:47], s65 offen offset:0  lds
    v_mfma_f32_16x16x32_bf16 v[148:151], a[44:47], a[64:67], 0
    s_waitcnt lgkmcnt(8)
    ds_read_b64_tr_b16 a[20:21], v19 offset:12416
    ds_read_b64_tr_b16 a[22:23], v19 offset:13952
    v_mfma_f32_16x16x32_bf16 v[156:159], a[44:47], a[68:71], 0
    buffer_load_dwordx4 v6, s[44:47], s65 offen offset:1024  lds
    v_mfma_f32_16x16x32_bf16 v[64:67], a[0:3], a[72:75], v[64:67]
    s_waitcnt lgkmcnt(8)
    ds_read_b64_tr_b16 a[24:25], v20 offset:12416
    ds_read_b64_tr_b16 a[26:27], v20 offset:13952
    v_mfma_f32_16x16x32_bf16 v[72:75], a[0:3], a[76:79], v[72:75]
    v_mfma_f32_16x16x32_bf16 v[68:71], a[4:7], a[72:75], v[68:71]
    s_waitcnt lgkmcnt(8)
    ds_read_b64_tr_b16 a[28:29], v21 offset:12416
    ds_read_b64_tr_b16 a[30:31], v21 offset:13952
    v_mfma_f32_16x16x32_bf16 v[76:79], a[4:7], a[76:79], v[76:79]
    buffer_load_dwordx4 v7, s[44:47], s65 offen offset:2048  lds
    v_mfma_f32_16x16x32_bf16 v[80:83], a[8:11], a[72:75], v[80:83]
    s_waitcnt lgkmcnt(8)
    ds_read_b64_tr_b16 a[32:33], v18 offset:12544
    ds_read_b64_tr_b16 a[34:35], v18 offset:14080
    v_mfma_f32_16x16x32_bf16 v[88:91], a[8:11], a[76:79], v[88:91]
    s_add_u32 m0, s8, 12288
    s_nop 0
    buffer_load_dwordx4 v12, s[36:39], s11 offen offset:0  lds
    v_mfma_f32_16x16x32_bf16 v[84:87], a[12:15], a[72:75], v[84:87]
    s_waitcnt lgkmcnt(8)
    ds_read_b64_tr_b16 a[36:37], v19 offset:12544
    ds_read_b64_tr_b16 a[38:39], v19 offset:14080
    v_mfma_f32_16x16x32_bf16 v[92:95], a[12:15], a[76:79], v[92:95]
    buffer_load_dwordx4 v13, s[36:39], s11 offen offset:1024  lds
    v_mfma_f32_16x16x32_bf16 v[96:99], a[16:19], a[72:75], v[96:99]
    s_waitcnt lgkmcnt(8)
    ds_read_b64_tr_b16 a[40:41], v20 offset:12544
    ds_read_b64_tr_b16 a[42:43], v20 offset:14080
    v_mfma_f32_16x16x32_bf16 v[104:107], a[16:19], a[76:79], v[104:107]
    buffer_load_dwordx4 v14, s[36:39], s11 offen offset:2048  lds
    v_mfma_f32_16x16x32_bf16 v[100:103], a[20:23], a[72:75], v[100:103]
    s_waitcnt lgkmcnt(8)
    ds_read_b64_tr_b16 a[44:45], v21 offset:12544
    ds_read_b64_tr_b16 a[46:47], v21 offset:14080
    v_mfma_f32_16x16x32_bf16 v[108:111], a[20:23], a[76:79], v[108:111]
    buffer_load_dwordx4 v15, s[36:39], s11 offen offset:3072  lds
    v_mfma_f32_16x16x32_bf16 v[112:115], a[24:27], a[72:75], v[112:115]
    s_waitcnt vmcnt(10)
    s_barrier
    s_waitcnt lgkmcnt(8)
    ds_read_b128 a[80:83], v16 offset:4096
    ds_read_b128 a[84:87], v16 offset:6144
    v_mfma_f32_16x16x32_bf16 v[120:123], a[24:27], a[76:79], v[120:123]
    ds_read_b128 a[88:91], v17 offset:4096
    v_mfma_f32_16x16x32_bf16 v[116:119], a[28:31], a[72:75], v[116:119]
    s_waitcnt lgkmcnt(9)
    ds_read_b128 a[92:95], v17 offset:6144
    ds_read_b64_tr_b16 a[0:1], v18 offset:24576
    v_mfma_f32_16x16x32_bf16 v[124:127], a[28:31], a[76:79], v[124:127]
    ds_read_b64_tr_b16 a[2:3], v18 offset:26112
    s_or_b32 s13, s48, s3
    s_cmp_lg_u32 s13, 0
    s_cbranch_scc1 L_nonce
    s_waitcnt lgkmcnt(0)
    s_lshr_b32 s49, s49, 16
    s_and_b32 s13, s16, 0xfff
    s_add_u32 s49, s49, s13
    s_add_u32 s49, s49, 1
    s_and_b32 s49, s49, 0x1fff
    s_or_b32 s49, s49, 0x4000
    s_lshl_b32 s49, s49, 16
    s_bfe_u32 s13, s16, 0x10000c
    s_or_b32 s49, s49, s13
    s_atomic_add s49, s[60:61], 0
L_nonce:
    v_mfma_f32_16x16x32_bf16 v[128:131], a[32:35], a[72:75], v[128:131]
    s_waitcnt lgkmcnt(10)
    ds_read_b64_tr_b16 a[4:5], v19 offset:24576
    ds_read_b64_tr_b16 a[6:7], v19 offset:26112
    v_mfma_f32_16x16x32_bf16 v[136:139], a[32:35], a[76:79], v[136:139]
    ds_read_b64_tr_b16 a[8:9], v20 offset:24576
    v_mfma_f32_16x16x32_bf16 v[132:135], a[36:39], a[72:75], v[132:135]
    s_waitcnt lgkmcnt(11)
    ds_read_b64_tr_b16 a[10:11], v20 offset:26112
    ds_read_b64_tr_b16 a[12:13], v21 offset:24576
    v_mfma_f32_16x16x32_bf16 v[140:143], a[36:39], a[76:79], v[140:143]
    ds_read_b64_tr_b16 a[14:15], v21 offset:26112
    s_add_u32 m0, s8, 0
    s_add_u32 s66, s27, 256
    buffer_load_dwordx4 v8, s[32:35], s66 offen offset:0  lds
    v_mfma_f32_16x16x32_bf16 v[144:147], a[40:43], a[72:75], v[144:147]
    s_waitcnt lgkmcnt(12)
    ds_read_b64_tr_b16 a[16:17], v18 offset:24704
    ds_read_b64_tr_b16 a[18:19], v18 offset:26240
    v_mfma_f32_16x16x32_bf16 v[152:155], a[40:43], a[76:79], v[152:155]
    ds_read_b64_tr_b16 a[20:21], v19 offset:24704
    v_mfma_f32_16x16x32_bf16 v[148:151], a[44:47], a[72:75], v[148:151]
    s_waitcnt lgkmcnt(9)
    ds_read_b64_tr_b16 a[22:23], v19 offset:26240
    v_mfma_f32_16x16x32_bf16 v[156:159], a[44:47], a[76:79], v[156:159]
    buffer_load_dwordx4 v9, s[32:35], s66 offen offset:1024  lds
    v_mfma_f32_16x16x32_bf16 v[64:67], a[0:3], a[80:83], v[64:67]
    s_waitcnt lgkmcnt(8)
    ds_read_b64_tr_b16 a[24:25], v20 offset:24704
    ds_read_b64_tr_b16 a[26:27], v20 offset:26240
    v_mfma_f32_16x16x32_bf16 v[72:75], a[0:3], a[84:87], v[72:75]
    v_mfma_f32_16x16x32_bf16 v[68:71], a[4:7], a[80:83], v[68:71]
    s_waitcnt lgkmcnt(8)
    ds_read_b64_tr_b16 a[28:29], v21 offset:24704
    ds_read_b64_tr_b16 a[30:31], v21 offset:26240
    v_mfma_f32_16x16x32_bf16 v[76:79], a[4:7], a[84:87], v[76:79]
    buffer_load_dwordx4 v10, s[32:35], s66 offen offset:2048  lds
    v_mfma_f32_16x16x32_bf16 v[80:83], a[8:11], a[80:83], v[80:83]
    s_waitcnt lgkmcnt(8)
    ds_read_b64_tr_b16 a[32:33], v18 offset:24832
    ds_read_b64_tr_b16 a[34:35], v18 offset:26368
    v_mfma_f32_16x16x32_bf16 v[88:91], a[8:11], a[84:87], v[88:91]
    v_mfma_f32_16x16x32_bf16 v[84:87], a[12:15], a[80:83], v[84:87]
    s_waitcnt lgkmcnt(8)
    ds_read_b64_tr_b16 a[36:37], v19 offset:24832
    ds_read_b64_tr_b16 a[38:39], v19 offset:26368
    v_mfma_f32_16x16x32_bf16 v[92:95], a[12:15], a[84:87], v[92:95]
    buffer_load_dwordx4 v11, s[32:35], s66 offen offset:3072  lds
    v_mfma_f32_16x16x32_bf16 v[96:99], a[16:19], a[80:83], v[96:99]
    s_waitcnt lgkmcnt(8)
    ds_read_b64_tr_b16 a[40:41], v20 offset:24832
    ds_read_b64_tr_b16 a[42:43], v20 offset:26368
    v_mfma_f32_16x16x32_bf16 v[104:107], a[16:19], a[84:87], v[104:107]
    v_mfma_f32_16x16x32_bf16 v[100:103], a[20:23], a[80:83], v[100:103]
    s_waitcnt lgkmcnt(8)
    ds_read_b64_tr_b16 a[44:45], v21 offset:24832
    ds_read_b64_tr_b16 a[46:47], v21 offset:26368
    v_mfma_f32_16x16x32_bf16 v[108:111], a[20:23], a[84:87], v[108:111]
    s_add_u32 m0, s12, 73728
    s_add_u32 s67, s21, 1572864
    buffer_load_dwordx4 v2, s[44:47], s67 offen offset:0  lds
    v_mfma_f32_16x16x32_bf16 v[112:115], a[24:27], a[80:83], v[112:115]
    s_waitcnt lgkmcnt(8)
    ds_read_b64_tr_b16 a[0:1], v18 offset:36864
    ds_read_b64_tr_b16 a[2:3], v18 offset:38400
    v_mfma_f32_16x16x32_bf16 v[120:123], a[24:27], a[84:87], v[120:123]
    v_mfma_f32_16x16x32_bf16 v[116:119], a[28:31], a[80:83], v[116:119]
    s_waitcnt lgkmcnt(8)
    ds_read_b64_tr_b16 a[4:5], v19 offset:36864
    ds_read_b64_tr_b16 a[6:7], v19 offset:38400
    v_mfma_f32_16x16x32_bf16 v[124:127], a[28:31], a[84:87], v[124:127]
    buffer_load_dwordx4 v3, s[44:47], s67 offen offset:1024  lds
    v_mfma_f32_16x16x32_bf16 v[128:131], a[32:35], a[80:83], v[128:131]
    s_waitcnt lgkmcnt(8)
    ds_read_b64_tr_b16 a[8:9], v20 offset:36864
    ds_read_b64_tr_b16 a[10:11], v20 offset:38400
    v_mfma_f32_16x16x32_bf16 v[136:139], a[32:35], a[84:87], v[136:139]
    v_mfma_f32_16x16x32_bf16 v[132:135], a[36:39], a[80:83], v[132:135]
    s_waitcnt lgkmcnt(8)
    ds_read_b64_tr_b16 a[12:13], v21 offset:36864
    ds_read_b64_tr_b16 a[14:15], v21 offset:38400
    v_mfma_f32_16x16x32_bf16 v[140:143], a[36:39], a[84:87], v[140:143]
    buffer_load_dwordx4 v4, s[44:47], s67 offen offset:2048  lds
    v_mfma_f32_16x16x32_bf16 v[144:147], a[40:43], a[80:83], v[144:147]
    s_waitcnt lgkmcnt(8)
    ds_read_b64_tr_b16 a[16:17], v18 offset:36992
    ds_read_b64_tr_b16 a[18:19], v18 offset:38528
    v_mfma_f32_16x16x32_bf16 v[152:155], a[40:43], a[84:87], v[152:155]
    v_mfma_f32_16x16x32_bf16 v[148:151], a[44:47], a[80:83], v[148:151]
    s_waitcnt lgkmcnt(8)
    ds_read_b64_tr_b16 a[20:21], v19 offset:36992
    ds_read_b64_tr_b16 a[22:23], v19 offset:38528
    v_mfma_f32_16x16x32_bf16 v[156:159], a[44:47], a[84:87], v[156:159]
    s_add_u32 m0, s12, 76800
    s_nop 0
    buffer_load_dwordx4 v5, s[44:47], s67 offen offset:0  lds
    v_mfma_f32_16x16x32_bf16 v[64:67], a[0:3], a[88:91], v[64:67]
    s_waitcnt lgkmcnt(8)
    ds_read_b64_tr_b16 a[24:25], v20 offset:36992
    ds_read_b64_tr_b16 a[26:27], v20 offset:38528
    v_mfma_f32_16x16x32_bf16 v[72:75], a[0:3], a[92:95], v[72:75]
    v_mfma_f32_16x16x32_bf16 v[68:71], a[4:7], a[88:91], v[68:71]
    s_waitcnt lgkmcnt(8)
    ds_read_b64_tr_b16 a[28:29], v21 offset:36992
    ds_read_b64_tr_b16 a[30:31], v21 offset:38528
    v_mfma_f32_16x16x32_bf16 v[76:79], a[4:7], a[92:95], v[76:79]
    v_mfma_f32_16x16x32_bf16 v[80:83], a[8:11], a[88:91], v[80:83]
    s_waitcnt lgkmcnt(8)
    ds_read_b64_tr_b16 a[32:33], v18 offset:37120
    ds_read_b64_tr_b16 a[34:35], v18 offset:38656
    v_mfma_f32_16x16x32_bf16 v[88:91], a[8:11], a[92:95], v[88:91]
    buffer_load_dwordx4 v6, s[44:47], s67 offen offset:1024  lds
    v_mfma_f32_16x16x32_bf16 v[84:87], a[12:15], a[88:91], v[84:87]
    s_waitcnt lgkmcnt(8)
    ds_read_b64_tr_b16 a[36:37], v19 offset:37120
    ds_read_b64_tr_b16 a[38:39], v19 offset:38656
    v_mfma_f32_16x16x32_bf16 v[92:95], a[12:15], a[92:95], v[92:95]
    v_mfma_f32_16x16x32_bf16 v[96:99], a[16:19], a[88:91], v[96:99]
    s_waitcnt lgkmcnt(8)
    ds_read_b64_tr_b16 a[40:41], v20 offset:37120
    ds_read_b64_tr_b16 a[42:43], v20 offset:38656
    v_mfma_f32_16x16x32_bf16 v[104:107], a[16:19], a[92:95], v[104:107]
    v_mfma_f32_16x16x32_bf16 v[100:103], a[20:23], a[88:91], v[100:103]
    s_waitcnt lgkmcnt(8)
    ds_read_b64_tr_b16 a[44:45], v21 offset:37120
    ds_read_b64_tr_b16 a[46:47], v21 offset:38656
    v_mfma_f32_16x16x32_bf16 v[108:111], a[20:23], a[92:95], v[108:111]
    buffer_load_dwordx4 v7, s[44:47], s67 offen offset:2048  lds
    v_mfma_f32_16x16x32_bf16 v[112:115], a[24:27], a[88:91], v[112:115]
    s_waitcnt vmcnt(14)
    s_barrier
    s_waitcnt lgkmcnt(8)
    ds_read_b128 a[64:67], v16 offset:8192
    ds_read_b128 a[68:71], v16 offset:10240
    v_mfma_f32_16x16x32_bf16 v[120:123], a[24:27], a[92:95], v[120:123]
    ds_read_b128 a[72:75], v17 offset:8192
    v_mfma_f32_16x16x32_bf16 v[116:119], a[28:31], a[88:91], v[116:119]
    s_waitcnt lgkmcnt(9)
    ds_read_b128 a[76:79], v17 offset:10240
    ds_read_b64_tr_b16 a[0:1], v22 offset:0
    v_mfma_f32_16x16x32_bf16 v[124:127], a[28:31], a[92:95], v[124:127]
    ds_read_b64_tr_b16 a[2:3], v22 offset:1536
    s_add_u32 m0, s8, 4096
    s_add_u32 s64, s28, 256
    buffer_load_dwordx4 v8, s[32:35], s64 offen offset:0  lds
    v_mfma_f32_16x16x32_bf16 v[128:131], a[32:35], a[88:91], v[128:131]
    s_waitcnt lgkmcnt(10)
    ds_read_b64_tr_b16 a[4:5], v23 offset:0
    ds_read_b64_tr_b16 a[6:7], v23 offset:1536
    v_mfma_f32_16x16x32_bf16 v[136:139], a[32:35], a[92:95], v[136:139]
    ds_read_b64_tr_b16 a[8:9], v30 offset:0
    v_mfma_f32_16x16x32_bf16 v[132:135], a[36:39], a[88:91], v[132:135]
    s_waitcnt lgkmcnt(11)
    ds_read_b64_tr_b16 a[10:11], v30 offset:1536
    ds_read_b64_tr_b16 a[12:13], v31 offset:0
    v_mfma_f32_16x16x32_bf16 v[140:143], a[36:39], a[92:95], v[140:143]
    ds_read_b64_tr_b16 a[14:15], v31 offset:1536
    buffer_load_dwordx4 v9, s[32:35], s64 offen offset:1024  lds
    v_mfma_f32_16x16x32_bf16 v[144:147], a[40:43], a[88:91], v[144:147]
    s_waitcnt lgkmcnt(12)
    ds_read_b64_tr_b16 a[16:17], v22 offset:128
    ds_read_b64_tr_b16 a[18:19], v22 offset:1664
    v_mfma_f32_16x16x32_bf16 v[152:155], a[40:43], a[92:95], v[152:155]
    ds_read_b64_tr_b16 a[20:21], v23 offset:128
    v_mfma_f32_16x16x32_bf16 v[148:151], a[44:47], a[88:91], v[148:151]
    s_waitcnt lgkmcnt(9)
    ds_read_b64_tr_b16 a[22:23], v23 offset:1664
    v_mfma_f32_16x16x32_bf16 v[156:159], a[44:47], a[92:95], v[156:159]
    buffer_load_dwordx4 v10, s[32:35], s64 offen offset:2048  lds
    v_mfma_f32_16x16x32_bf16 v[64:67], a[0:3], a[64:67], v[64:67]
    s_waitcnt lgkmcnt(8)
    ds_read_b64_tr_b16 a[24:25], v30 offset:128
    ds_read_b64_tr_b16 a[26:27], v30 offset:1664
    v_mfma_f32_16x16x32_bf16 v[72:75], a[0:3], a[68:71], v[72:75]
    v_mfma_f32_16x16x32_bf16 v[68:71], a[4:7], a[64:67], v[68:71]
    s_waitcnt lgkmcnt(8)
    ds_read_b64_tr_b16 a[28:29], v31 offset:128
    ds_read_b64_tr_b16 a[30:31], v31 offset:1664
    v_mfma_f32_16x16x32_bf16 v[76:79], a[4:7], a[68:71], v[76:79]
    buffer_load_dwordx4 v11, s[32:35], s64 offen offset:3072  lds
    v_mfma_f32_16x16x32_bf16 v[80:83], a[8:11], a[64:67], v[80:83]
    s_waitcnt lgkmcnt(8)
    ds_read_b64_tr_b16 a[32:33], v22 offset:256
    ds_read_b64_tr_b16 a[34:35], v22 offset:1792
    v_mfma_f32_16x16x32_bf16 v[88:91], a[8:11], a[68:71], v[88:91]
    v_mfma_f32_16x16x32_bf16 v[84:87], a[12:15], a[64:67], v[84:87]
    s_waitcnt lgkmcnt(8)
    ds_read_b64_tr_b16 a[36:37], v23 offset:256
    ds_read_b64_tr_b16 a[38:39], v23 offset:1792
    v_mfma_f32_16x16x32_bf16 v[92:95], a[12:15], a[68:71], v[92:95]
    s_add_u32 m0, s12, 0
    s_add_u32 s65, s22, 1572864
    buffer_load_dwordx4 v2, s[44:47], s65 offen offset:0  lds
    v_mfma_f32_16x16x32_bf16 v[96:99], a[16:19], a[64:67], v[96:99]
    s_waitcnt lgkmcnt(8)
    ds_read_b64_tr_b16 a[40:41], v30 offset:256
    ds_read_b64_tr_b16 a[42:43], v30 offset:1792
    v_mfma_f32_16x16x32_bf16 v[104:107], a[16:19], a[68:71], v[104:107]
    v_mfma_f32_16x16x32_bf16 v[100:103], a[20:23], a[64:67], v[100:103]
    s_waitcnt lgkmcnt(8)
    ds_read_b64_tr_b16 a[44:45], v31 offset:256
    ds_read_b64_tr_b16 a[46:47], v31 offset:1792
    v_mfma_f32_16x16x32_bf16 v[108:111], a[20:23], a[68:71], v[108:111]
    buffer_load_dwordx4 v3, s[44:47], s65 offen offset:1024  lds
    v_mfma_f32_16x16x32_bf16 v[112:115], a[24:27], a[64:67], v[112:115]
    s_waitcnt lgkmcnt(8)
    ds_read_b64_tr_b16 a[0:1], v22 offset:12288
    ds_read_b64_tr_b16 a[2:3], v22 offset:13824
    v_mfma_f32_16x16x32_bf16 v[120:123], a[24:27], a[68:71], v[120:123]
    v_mfma_f32_16x16x32_bf16 v[116:119], a[28:31], a[64:67], v[116:119]
    s_waitcnt lgkmcnt(8)
    ds_read_b64_tr_b16 a[4:5], v23 offset:12288
    ds_read_b64_tr_b16 a[6:7], v23 offset:13824
    v_mfma_f32_16x16x32_bf16 v[124:127], a[28:31], a[68:71], v[124:127]
    v_mfma_f32_16x16x32_bf16 v[128:131], a[32:35], a[64:67], v[128:131]
    s_waitcnt lgkmcnt(8)
    ds_read_b64_tr_b16 a[8:9], v30 offset:12288
    ds_read_b64_tr_b16 a[10:11], v30 offset:13824
    v_mfma_f32_16x16x32_bf16 v[136:139], a[32:35], a[68:71], v[136:139]
    buffer_load_dwordx4 v4, s[44:47], s65 offen offset:2048  lds
    v_mfma_f32_16x16x32_bf16 v[132:135], a[36:39], a[64:67], v[132:135]
    s_waitcnt lgkmcnt(8)
    ds_read_b64_tr_b16 a[12:13], v31 offset:12288
    ds_read_b64_tr_b16 a[14:15], v31 offset:13824
    v_mfma_f32_16x16x32_bf16 v[140:143], a[36:39], a[68:71], v[140:143]
    v_mfma_f32_16x16x32_bf16 v[144:147], a[40:43], a[64:67], v[144:147]
    s_waitcnt lgkmcnt(8)
    ds_read_b64_tr_b16 a[16:17], v22 offset:12416
    ds_read_b64_tr_b16 a[18:19], v22 offset:13952
    v_mfma_f32_16x16x32_bf16 v[152:155], a[40:43], a[68:71], v[152:155]
    v_mfma_f32_16x16x32_bf16 v[148:151], a[44:47], a[64:67], v[148:151]
    s_waitcnt lgkmcnt(8)
    ds_read_b64_tr_b16 a[20:21], v23 offset:12416
    ds_read_b64_tr_b16 a[22:23], v23 offset:13952
    v_mfma_f32_16x16x32_bf16 v[156:159], a[44:47], a[68:71], v[156:159]
    s_add_u32 m0, s12, 3072
    s_nop 0
    buffer_load_dwordx4 v5, s[44:47], s65 offen offset:0  lds
    v_mfma_f32_16x16x32_bf16 v[64:67], a[0:3], a[72:75], v[64:67]
    s_waitcnt lgkmcnt(8)
    ds_read_b64_tr_b16 a[24:25], v30 offset:12416
    ds_read_b64_tr_b16 a[26:27], v30 offset:13952
    v_mfma_f32_16x16x32_bf16 v[72:75], a[0:3], a[76:79], v[72:75]
    v_mfma_f32_16x16x32_bf16 v[68:71], a[4:7], a[72:75], v[68:71]
    s_waitcnt lgkmcnt(8)
    ds_read_b64_tr_b16 a[28:29], v31 offset:12416
    ds_read_b64_tr_b16 a[30:31], v31 offset:13952
    v_mfma_f32_16x16x32_bf16 v[76:79], a[4:7], a[76:79], v[76:79]
    v_mfma_f32_16x16x32_bf16 v[80:83], a[8:11], a[72:75], v[80:83]
    s_waitcnt lgkmcnt(8)
    ds_read_b64_tr_b16 a[32:33], v22 offset:12544
    ds_read_b64_tr_b16 a[34:35], v22 offset:14080
    v_mfma_f32_16x16x32_bf16 v[88:91], a[8:11], a[76:79], v[88:91]
    buffer_load_dwordx4 v6, s[44:47], s65 offen offset:1024  lds
    v_mfma_f32_16x16x32_bf16 v[84:87], a[12:15], a[72:75], v[84:87]
    s_waitcnt lgkmcnt(8)
    ds_read_b64_tr_b16 a[36:37], v23 offset:12544
    ds_read_b64_tr_b16 a[38:39], v23 offset:14080
    v_mfma_f32_16x16x32_bf16 v[92:95], a[12:15], a[76:79], v[92:95]
    v_mfma_f32_16x16x32_bf16 v[96:99], a[16:19], a[72:75], v[96:99]
    s_waitcnt lgkmcnt(8)
    ds_read_b64_tr_b16 a[40:41], v30 offset:12544
    ds_read_b64_tr_b16 a[42:43], v30 offset:14080
    v_mfma_f32_16x16x32_bf16 v[104:107], a[16:19], a[76:79], v[104:107]
    v_mfma_f32_16x16x32_bf16 v[100:103], a[20:23], a[72:75], v[100:103]
    s_waitcnt lgkmcnt(8)
    ds_read_b64_tr_b16 a[44:45], v31 offset:12544
    ds_read_b64_tr_b16 a[46:47], v31 offset:14080
    v_mfma_f32_16x16x32_bf16 v[108:111], a[20:23], a[76:79], v[108:111]
    buffer_load_dwordx4 v7, s[44:47], s65 offen offset:2048  lds
    v_mfma_f32_16x16x32_bf16 v[112:115], a[24:27], a[72:75], v[112:115]
    s_waitcnt vmcnt(10)
    s_barrier
    s_waitcnt lgkmcnt(8)
    ds_read_b128 a[80:83], v16 offset:0
    ds_read_b128 a[84:87], v16 offset:2048
    v_mfma_f32_16x16x32_bf16 v[120:123], a[24:27], a[76:79], v[120:123]
    ds_read_b128 a[88:91], v17 offset:0
    v_mfma_f32_16x16x32_bf16 v[116:119], a[28:31], a[72:75], v[116:119]
    s_waitcnt lgkmcnt(9)
    ds_read_b128 a[92:95], v17 offset:2048
    ds_read_b64_tr_b16 a[0:1], v22 offset:24576
    v_mfma_f32_16x16x32_bf16 v[124:127], a[28:31], a[76:79], v[124:127]
    ds_read_b64_tr_b16 a[2:3], v22 offset:26112
    s_add_u32 m0, s8, 8192
    s_add_u32 s66, s29, 256
    buffer_load_dwordx4 v8, s[32:35], s66 offen offset:0  lds
    v_mfma_f32_16x16x32_bf16 v[128:131], a[32:35], a[72:75], v[128:131]
    s_waitcnt lgkmcnt(10)
    ds_read_b64_tr_b16 a[4:5], v23 offset:24576
    ds_read_b64_tr_b16 a[6:7], v23 offset:26112
    v_mfma_f32_16x16x32_bf16 v[136:139], a[32:35], a[76:79], v[136:139]
    ds_read_b64_tr_b16 a[8:9], v30 offset:24576
    v_mfma_f32_16x16x32_bf16 v[132:135], a[36:39], a[72:75], v[132:135]
    s_waitcnt lgkmcnt(11)
    ds_read_b64_tr_b16 a[10:11], v30 offset:26112
    ds_read_b64_tr_b16 a[12:13], v31 offset:24576
    v_mfma_f32_16x16x32_bf16 v[140:143], a[36:39], a[76:79], v[140:143]
    ds_read_b64_tr_b16 a[14:15], v31 offset:26112
    buffer_load_dwordx4 v9, s[32:35], s66 offen offset:1024  lds
    v_mfma_f32_16x16x32_bf16 v[144:147], a[40:43], a[72:75], v[144:147]
    s_waitcnt lgkmcnt(12)
    ds_read_b64_tr_b16 a[16:17], v22 offset:24704
    ds_read_b64_tr_b16 a[18:19], v22 offset:26240
    v_mfma_f32_16x16x32_bf16 v[152:155], a[40:43], a[76:79], v[152:155]
    ds_read_b64_tr_b16 a[20:21], v23 offset:24704
    v_mfma_f32_16x16x32_bf16 v[148:151], a[44:47], a[72:75], v[148:151]
    s_waitcnt lgkmcnt(9)
    ds_read_b64_tr_b16 a[22:23], v23 offset:26240
    v_mfma_f32_16x16x32_bf16 v[156:159], a[44:47], a[76:79], v[156:159]
    buffer_load_dwordx4 v10, s[32:35], s66 offen offset:2048  lds
    v_mfma_f32_16x16x32_bf16 v[64:67], a[0:3], a[80:83], v[64:67]
    s_waitcnt lgkmcnt(8)
    ds_read_b64_tr_b16 a[24:25], v30 offset:24704
    ds_read_b64_tr_b16 a[26:27], v30 offset:26240
    v_mfma_f32_16x16x32_bf16 v[72:75], a[0:3], a[84:87], v[72:75]
    v_mfma_f32_16x16x32_bf16 v[68:71], a[4:7], a[80:83], v[68:71]
    s_waitcnt lgkmcnt(8)
    ds_read_b64_tr_b16 a[28:29], v31 offset:24704
    ds_read_b64_tr_b16 a[30:31], v31 offset:26240
    v_mfma_f32_16x16x32_bf16 v[76:79], a[4:7], a[84:87], v[76:79]
    buffer_load_dwordx4 v11, s[32:35], s66 offen offset:3072  lds
    v_mfma_f32_16x16x32_bf16 v[80:83], a[8:11], a[80:83], v[80:83]
    s_waitcnt lgkmcnt(8)
    ds_read_b64_tr_b16 a[32:33], v22 offset:24832
    ds_read_b64_tr_b16 a[34:35], v22 offset:26368
    v_mfma_f32_16x16x32_bf16 v[88:91], a[8:11], a[84:87], v[88:91]
    v_mfma_f32_16x16x32_bf16 v[84:87], a[12:15], a[80:83], v[84:87]
    s_waitcnt lgkmcnt(8)
    ds_read_b64_tr_b16 a[36:37], v23 offset:24832
    ds_read_b64_tr_b16 a[38:39], v23 offset:26368
    v_mfma_f32_16x16x32_bf16 v[92:95], a[12:15], a[84:87], v[92:95]
    s_add_u32 m0, s12, 24576
    s_add_u32 s67, s23, 1572864
    buffer_load_dwordx4 v2, s[44:47], s67 offen offset:0  lds
    v_mfma_f32_16x16x32_bf16 v[96:99], a[16:19], a[80:83], v[96:99]
    s_waitcnt lgkmcnt(8)
    ds_read_b64_tr_b16 a[40:41], v30 offset:24832
    ds_read_b64_tr_b16 a[42:43], v30 offset:26368
    v_mfma_f32_16x16x32_bf16 v[104:107], a[16:19], a[84:87], v[104:107]
    v_mfma_f32_16x16x32_bf16 v[100:103], a[20:23], a[80:83], v[100:103]
    s_waitcnt lgkmcnt(8)
    ds_read_b64_tr_b16 a[44:45], v31 offset:24832
    ds_read_b64_tr_b16 a[46:47], v31 offset:26368
    v_mfma_f32_16x16x32_bf16 v[108:111], a[20:23], a[84:87], v[108:111]
    buffer_load_dwordx4 v3, s[44:47], s67 offen offset:1024  lds
    v_mfma_f32_16x16x32_bf16 v[112:115], a[24:27], a[80:83], v[112:115]
    s_waitcnt lgkmcnt(8)
    ds_read_b64_tr_b16 a[0:1], v22 offset:36864
    ds_read_b64_tr_b16 a[2:3], v22 offset:38400
    v_mfma_f32_16x16x32_bf16 v[120:123], a[24:27], a[84:87], v[120:123]
    v_mfma_f32_16x16x32_bf16 v[116:119], a[28:31], a[80:83], v[116:119]
    s_waitcnt lgkmcnt(8)
    ds_read_b64_tr_b16 a[4:5], v23 offset:36864
    ds_read_b64_tr_b16 a[6:7], v23 offset:38400
    v_mfma_f32_16x16x32_bf16 v[124:127], a[28:31], a[84:87], v[124:127]
    v_mfma_f32_16x16x32_bf16 v[128:131], a[32:35], a[80:83], v[128:131]
    s_waitcnt lgkmcnt(8)
    ds_read_b64_tr_b16 a[8:9], v30 offset:36864
    ds_read_b64_tr_b16 a[10:11], v30 offset:38400
    v_mfma_f32_16x16x32_bf16 v[136:139], a[32:35], a[84:87], v[136:139]
    s_waitcnt vmcnt(26)
    ds_read_b64 a[96:97], v160 offset:12288
    buffer_load_dwordx4 v4, s[44:47], s67 offen offset:2048  lds
    ds_read_b64 a[98:99], v161 offset:12288
    ds_read_b64 a[100:101], v160 offset:14336
    v_mfma_f32_16x16x32_bf16 v[132:135], a[36:39], a[80:83], v[132:135]
    s_waitcnt lgkmcnt(11)
    ds_read_b64_tr_b16 a[12:13], v31 offset:36864
    ds_read_b64_tr_b16 a[14:15], v31 offset:38400
    v_mfma_f32_16x16x32_bf16 v[140:143], a[36:39], a[84:87], v[140:143]
    v_mfma_f32_16x16x32_bf16 v[144:147], a[40:43], a[80:83], v[144:147]
    s_waitcnt lgkmcnt(11)
    ds_read_b64_tr_b16 a[16:17], v22 offset:36992
    ds_read_b64_tr_b16 a[18:19], v22 offset:38528
    v_mfma_f32_16x16x32_bf16 v[152:155], a[40:43], a[84:87], v[152:155]
    ds_read_b64 a[102:103], v161 offset:14336
    ds_read_b64 a[104:105], v162 offset:12288
    v_mfma_f32_16x16x32_bf16 v[148:151], a[44:47], a[80:83], v[148:151]
    s_waitcnt lgkmcnt(13)
    ds_read_b64_tr_b16 a[20:21], v23 offset:36992
    ds_read_b64_tr_b16 a[22:23], v23 offset:38528
    v_mfma_f32_16x16x32_bf16 v[156:159], a[44:47], a[84:87], v[156:159]
    ds_read_b64 a[106:107], v163 offset:12288
    ds_read_b64 a[108:109], v162 offset:14336
    s_add_u32 m0, s12, 27648
    s_nop 0
    buffer_load_dwordx4 v5, s[44:47], s67 offen offset:0  lds
    ds_read_b64 a[110:111], v163 offset:14336
    v_mfma_f32_16x16x32_bf16 v[64:67], a[0:3], a[88:91], v[64:67]
    s_waitcnt lgkmcnt(15)
    ds_read_b64_tr_b16 a[24:25], v30 offset:36992
    ds_read_b64_tr_b16 a[26:27], v30 offset:38528
    v_mfma_f32_16x16x32_bf16 v[72:75], a[0:3], a[92:95], v[72:75]
    v_mfma_f32_16x16x32_bf16 v[68:71], a[4:7], a[88:91], v[68:71]
    s_waitcnt lgkmcnt(15)
    ds_read_b64_tr_b16 a[28:29], v31 offset:36992
    ds_read_b64_tr_b16 a[30:31], v31 offset:38528
    v_mfma_f32_16x16x32_bf16 v[76:79], a[4:7], a[92:95], v[76:79]
    v_mfma_f32_16x16x32_bf16 v[80:83], a[8:11], a[88:91], v[80:83]
    s_waitcnt lgkmcnt(13)
    ds_read_b64_tr_b16 a[32:33], v22 offset:37120
    ds_read_b64_tr_b16 a[34:35], v22 offset:38656
    v_mfma_f32_16x16x32_bf16 v[88:91], a[8:11], a[92:95], v[88:91]
    buffer_load_dwordx4 v6, s[44:47], s67 offen offset:1024  lds
    v_mfma_f32_16x16x32_bf16 v[84:87], a[12:15], a[88:91], v[84:87]
    s_waitcnt lgkmcnt(13)
    ds_read_b64_tr_b16 a[36:37], v23 offset:37120
    ds_read_b64_tr_b16 a[38:39], v23 offset:38656
    v_mfma_f32_16x16x32_bf16 v[92:95], a[12:15], a[92:95], v[92:95]
    v_mfma_f32_16x16x32_bf16 v[96:99], a[16:19], a[88:91], v[96:99]
    s_waitcnt lgkmcnt(11)
    ds_read_b64_tr_b16 a[40:41], v30 offset:37120
    ds_read_b64_tr_b16 a[42:43], v30 offset:38656
    v_mfma_f32_16x16x32_bf16 v[104:107], a[16:19], a[92:95], v[104:107]
    v_mfma_f32_16x16x32_bf16 v[100:103], a[20:23], a[88:91], v[100:103]
    s_waitcnt lgkmcnt(8)
    ds_read_b64_tr_b16 a[44:45], v31 offset:37120
    ds_read_b64_tr_b16 a[46:47], v31 offset:38656
    v_mfma_f32_16x16x32_bf16 v[108:111], a[20:23], a[92:95], v[108:111]
    buffer_load_dwordx4 v7, s[44:47], s67 offen offset:2048  lds
    v_mfma_f32_16x16x32_bf16 v[112:115], a[24:27], a[88:91], v[112:115]
    s_waitcnt vmcnt(10)
    s_barrier
    s_waitcnt lgkmcnt(8)
    ds_read_b128 a[64:67], v16 offset:4096
    ds_read_b128 a[68:71], v16 offset:6144
    v_mfma_f32_16x16x32_bf16 v[120:123], a[24:27], a[92:95], v[120:123]
    ds_read_b128 a[72:75], v17 offset:4096
    v_mfma_f32_16x16x32_bf16 v[116:119], a[28:31], a[88:91], v[116:119]
    s_waitcnt lgkmcnt(9)
    ds_read_b128 a[76:79], v17 offset:6144
    ds_read_b64_tr_b16 a[0:1], v18 offset:0
    v_mfma_f32_16x16x32_bf16 v[124:127], a[28:31], a[92:95], v[124:127]
    ds_read_b64_tr_b16 a[2:3], v18 offset:1536
    s_add_u32 m0, s8, 0
    s_add_u32 s64, s26, 768
    buffer_load_dwordx4 v8, s[32:35], s64 offen offset:0  lds
    v_mfma_f32_16x16x32_bf16 v[128:131], a[32:35], a[88:91], v[128:131]
    s_waitcnt lgkmcnt(10)
    ds_read_b64_tr_b16 a[4:5], v19 offset:0
    ds_read_b64_tr_b16 a[6:7], v19 offset:1536
    v_mfma_f32_16x16x32_bf16 v[136:139], a[32:35], a[92:95], v[136:139]
    ds_read_b64_tr_b16 a[8:9], v20 offset:0
    v_mfma_f32_16x16x32_bf16 v[132:135], a[36:39], a[88:91], v[132:135]
    s_waitcnt lgkmcnt(11)
    ds_read_b64_tr_b16 a[10:11], v20 offset:1536
    ds_read_b64_tr_b16 a[12:13], v21 offset:0
    v_mfma_f32_16x16x32_bf16 v[140:143], a[36:39], a[92:95], v[140:143]
    ds_read_b64_tr_b16 a[14:15], v21 offset:1536
    buffer_load_dwordx4 v9, s[32:35], s64 offen offset:1024  lds
    v_mfma_f32_16x16x32_bf16 v[144:147], a[40:43], a[88:91], v[144:147]
    s_waitcnt lgkmcnt(12)
    ds_read_b64_tr_b16 a[16:17], v18 offset:128
    ds_read_b64_tr_b16 a[18:19], v18 offset:1664
    v_mfma_f32_16x16x32_bf16 v[152:155], a[40:43], a[92:95], v[152:155]
    ds_read_b64_tr_b16 a[20:21], v19 offset:128
    v_mfma_f32_16x16x32_bf16 v[148:151], a[44:47], a[88:91], v[148:151]
    s_waitcnt lgkmcnt(9)
    ds_read_b64_tr_b16 a[22:23], v19 offset:1664
    v_mfma_f32_16x16x32_bf16 v[156:159], a[44:47], a[92:95], v[156:159]
    buffer_load_dwordx4 v10, s[32:35], s64 offen offset:2048  lds
    v_mfma_f32_16x16x32_bf16 v[64:67], a[0:3], a[64:67], v[64:67]
    s_waitcnt lgkmcnt(8)
    ds_read_b64_tr_b16 a[24:25], v20 offset:128
    ds_read_b64_tr_b16 a[26:27], v20 offset:1664
    v_mfma_f32_16x16x32_bf16 v[72:75], a[0:3], a[68:71], v[72:75]
    v_mfma_f32_16x16x32_bf16 v[68:71], a[4:7], a[64:67], v[68:71]
    s_waitcnt lgkmcnt(8)
    ds_read_b64_tr_b16 a[28:29], v21 offset:128
    ds_read_b64_tr_b16 a[30:31], v21 offset:1664
    v_mfma_f32_16x16x32_bf16 v[76:79], a[4:7], a[68:71], v[76:79]
    buffer_load_dwordx4 v11, s[32:35], s64 offen offset:3072  lds
    v_mfma_f32_16x16x32_bf16 v[80:83], a[8:11], a[64:67], v[80:83]
    s_waitcnt lgkmcnt(8)
    ds_read_b64_tr_b16 a[32:33], v18 offset:256
    ds_read_b64_tr_b16 a[34:35], v18 offset:1792
    v_mfma_f32_16x16x32_bf16 v[88:91], a[8:11], a[68:71], v[88:91]
    v_mfma_f32_16x16x32_bf16 v[84:87], a[12:15], a[64:67], v[84:87]
    s_waitcnt lgkmcnt(8)
    ds_read_b64_tr_b16 a[36:37], v19 offset:256
    ds_read_b64_tr_b16 a[38:39], v19 offset:1792
    v_mfma_f32_16x16x32_bf16 v[92:95], a[12:15], a[68:71], v[92:95]
    s_add_u32 m0, s12, 49152
    s_add_u32 s65, s20, 4718592
    buffer_load_dwordx4 v2, s[44:47], s65 offen offset:0  lds
    v_mfma_f32_16x16x32_bf16 v[96:99], a[16:19], a[64:67], v[96:99]
    s_waitcnt lgkmcnt(8)
    ds_read_b64_tr_b16 a[40:41], v20 offset:256
    ds_read_b64_tr_b16 a[42:43], v20 offset:1792
    v_mfma_f32_16x16x32_bf16 v[104:107], a[16:19], a[68:71], v[104:107]
    v_mfma_f32_16x16x32_bf16 v[100:103], a[20:23], a[64:67], v[100:103]
    s_waitcnt lgkmcnt(8)
    ds_read_b64_tr_b16 a[44:45], v21 offset:256
    ds_read_b64_tr_b16 a[46:47], v21 offset:1792
    v_mfma_f32_16x16x32_bf16 v[108:111], a[20:23], a[68:71], v[108:111]
    buffer_load_dwordx4 v3, s[44:47], s65 offen offset:1024  lds
    v_mfma_f32_16x16x32_bf16 v[112:115], a[24:27], a[64:67], v[112:115]
    s_waitcnt lgkmcnt(8)
    ds_read_b64_tr_b16 a[0:1], v18 offset:12288
    ds_read_b64_tr_b16 a[2:3], v18 offset:13824
    v_mfma_f32_16x16x32_bf16 v[120:123], a[24:27], a[68:71], v[120:123]
    v_mfma_f32_16x16x32_bf16 v[116:119], a[28:31], a[64:67], v[116:119]
    s_waitcnt lgkmcnt(8)
    ds_read_b64_tr_b16 a[4:5], v19 offset:12288
    ds_read_b64_tr_b16 a[6:7], v19 offset:13824
    v_mfma_f32_16x16x32_bf16 v[124:127], a[28:31], a[68:71], v[124:127]
    v_mfma_f32_16x16x32_bf16 v[128:131], a[32:35], a[64:67], v[128:131]
    s_waitcnt lgkmcnt(8)
    ds_read_b64_tr_b16 a[8:9], v20 offset:12288
    ds_read_b64_tr_b16 a[10:11], v20 offset:13824
    v_mfma_f32_16x16x32_bf16 v[136:139], a[32:35], a[68:71], v[136:139]
    buffer_load_dwordx4 v4, s[44:47], s65 offen offset:2048  lds
    v_mfma_f32_16x16x32_bf16 v[132:135], a[36:39], a[64:67], v[132:135]
    s_waitcnt lgkmcnt(8)
    ds_read_b64_tr_b16 a[12:13], v21 offset:12288
    ds_read_b64_tr_b16 a[14:15], v21 offset:13824
    v_mfma_f32_16x16x32_bf16 v[140:143], a[36:39], a[68:71], v[140:143]
    v_mfma_f32_16x16x32_bf16 v[144:147], a[40:43], a[64:67], v[144:147]
    s_waitcnt lgkmcnt(8)
    ds_read_b64_tr_b16 a[16:17], v18 offset:12416
    ds_read_b64_tr_b16 a[18:19], v18 offset:13952
    v_mfma_f32_16x16x32_bf16 v[152:155], a[40:43], a[68:71], v[152:155]
    v_mfma_f32_16x16x32_bf16 v[148:151], a[44:47], a[64:67], v[148:151]
    s_waitcnt lgkmcnt(8)
    ds_read_b64_tr_b16 a[20:21], v19 offset:12416
    ds_read_b64_tr_b16 a[22:23], v19 offset:13952
    v_mfma_f32_16x16x32_bf16 v[156:159], a[44:47], a[68:71], v[156:159]
    s_add_u32 m0, s12, 52224
    s_nop 0
    buffer_load_dwordx4 v5, s[44:47], s65 offen offset:0  lds
    v_mfma_f32_16x16x32_bf16 v[64:67], a[0:3], a[72:75], v[64:67]
    s_waitcnt lgkmcnt(8)
    ds_read_b64_tr_b16 a[24:25], v20 offset:12416
    ds_read_b64_tr_b16 a[26:27], v20 offset:13952
    v_mfma_f32_16x16x32_bf16 v[72:75], a[0:3], a[76:79], v[72:75]
    v_mfma_f32_16x16x32_bf16 v[68:71], a[4:7], a[72:75], v[68:71]
    s_waitcnt lgkmcnt(8)
    ds_read_b64_tr_b16 a[28:29], v21 offset:12416
    ds_read_b64_tr_b16 a[30:31], v21 offset:13952
    v_mfma_f32_16x16x32_bf16 v[76:79], a[4:7], a[76:79], v[76:79]
    v_mfma_f32_16x16x32_bf16 v[80:83], a[8:11], a[72:75], v[80:83]
    s_waitcnt lgkmcnt(8)
    ds_read_b64_tr_b16 a[32:33], v18 offset:12544
    ds_read_b64_tr_b16 a[34:35], v18 offset:14080
    v_mfma_f32_16x16x32_bf16 v[88:91], a[8:11], a[76:79], v[88:91]
    buffer_load_dwordx4 v6, s[44:47], s65 offen offset:1024  lds
    v_mfma_f32_16x16x32_bf16 v[84:87], a[12:15], a[72:75], v[84:87]
    s_waitcnt lgkmcnt(8)
    ds_read_b64_tr_b16 a[36:37], v19 offset:12544
    ds_read_b64_tr_b16 a[38:39], v19 offset:14080
    v_mfma_f32_16x16x32_bf16 v[92:95], a[12:15], a[76:79], v[92:95]
    v_mfma_f32_16x16x32_bf16 v[96:99], a[16:19], a[72:75], v[96:99]
    s_waitcnt lgkmcnt(8)
    ds_read_b64_tr_b16 a[40:41], v20 offset:12544
    ds_read_b64_tr_b16 a[42:43], v20 offset:14080
    v_mfma_f32_16x16x32_bf16 v[104:107], a[16:19], a[76:79], v[104:107]
    v_mfma_f32_16x16x32_bf16 v[100:103], a[20:23], a[72:75], v[100:103]
    s_waitcnt lgkmcnt(8)
    ds_read_b64_tr_b16 a[44:45], v21 offset:12544
    ds_read_b64_tr_b16 a[46:47], v21 offset:14080
    v_mfma_f32_16x16x32_bf16 v[108:111], a[20:23], a[76:79], v[108:111]
    buffer_load_dwordx4 v7, s[44:47], s65 offen offset:2048  lds
    v_mfma_f32_16x16x32_bf16 v[112:115], a[24:27], a[72:75], v[112:115]
    s_waitcnt vmcnt(10)
    s_barrier
    s_waitcnt lgkmcnt(8)
    ds_read_b128 a[80:83], v16 offset:8192
    ds_read_b128 a[84:87], v16 offset:10240
    v_mfma_f32_16x16x32_bf16 v[120:123], a[24:27], a[76:79], v[120:123]
    ds_read_b128 a[88:91], v17 offset:8192
    v_mfma_f32_16x16x32_bf16 v[116:119], a[28:31], a[72:75], v[116:119]
    s_waitcnt lgkmcnt(9)
    ds_read_b128 a[92:95], v17 offset:10240
    ds_read_b64_tr_b16 a[0:1], v18 offset:24576
    v_mfma_f32_16x16x32_bf16 v[124:127], a[28:31], a[76:79], v[124:127]
    ds_read_b64_tr_b16 a[2:3], v18 offset:26112
    s_add_u32 m0, s8, 4096
    s_add_u32 s66, s27, 768
    buffer_load_dwordx4 v8, s[32:35], s66 offen offset:0  lds
    v_mfma_f32_16x16x32_bf16 v[128:131], a[32:35], a[72:75], v[128:131]
    s_waitcnt lgkmcnt(10)
    ds_read_b64_tr_b16 a[4:5], v19 offset:24576
    ds_read_b64_tr_b16 a[6:7], v19 offset:26112
    v_mfma_f32_16x16x32_bf16 v[136:139], a[32:35], a[76:79], v[136:139]
    ds_read_b64_tr_b16 a[8:9], v20 offset:24576
    v_mfma_f32_16x16x32_bf16 v[132:135], a[36:39], a[72:75], v[132:135]
    s_waitcnt lgkmcnt(11)
    ds_read_b64_tr_b16 a[10:11], v20 offset:26112
    ds_read_b64_tr_b16 a[12:13], v21 offset:24576
    v_mfma_f32_16x16x32_bf16 v[140:143], a[36:39], a[76:79], v[140:143]
    ds_read_b64_tr_b16 a[14:15], v21 offset:26112
    buffer_load_dwordx4 v9, s[32:35], s66 offen offset:1024  lds
    v_mfma_f32_16x16x32_bf16 v[144:147], a[40:43], a[72:75], v[144:147]
    s_waitcnt lgkmcnt(12)
    ds_read_b64_tr_b16 a[16:17], v18 offset:24704
    ds_read_b64_tr_b16 a[18:19], v18 offset:26240
    v_mfma_f32_16x16x32_bf16 v[152:155], a[40:43], a[76:79], v[152:155]
    ds_read_b64_tr_b16 a[20:21], v19 offset:24704
    v_mfma_f32_16x16x32_bf16 v[148:151], a[44:47], a[72:75], v[148:151]
    s_waitcnt lgkmcnt(9)
    ds_read_b64_tr_b16 a[22:23], v19 offset:26240
    v_mfma_f32_16x16x32_bf16 v[156:159], a[44:47], a[76:79], v[156:159]
    buffer_load_dwordx4 v10, s[32:35], s66 offen offset:2048  lds
    v_mfma_f32_16x16x32_bf16 v[64:67], a[0:3], a[80:83], v[64:67]
    s_waitcnt lgkmcnt(8)
    ds_read_b64_tr_b16 a[24:25], v20 offset:24704
    ds_read_b64_tr_b16 a[26:27], v20 offset:26240
    v_mfma_f32_16x16x32_bf16 v[72:75], a[0:3], a[84:87], v[72:75]
    v_mfma_f32_16x16x32_bf16 v[68:71], a[4:7], a[80:83], v[68:71]
    s_waitcnt lgkmcnt(8)
    ds_read_b64_tr_b16 a[28:29], v21 offset:24704
    ds_read_b64_tr_b16 a[30:31], v21 offset:26240
    v_mfma_f32_16x16x32_bf16 v[76:79], a[4:7], a[84:87], v[76:79]
    buffer_load_dwordx4 v11, s[32:35], s66 offen offset:3072  lds
    v_mfma_f32_16x16x32_bf16 v[80:83], a[8:11], a[80:83], v[80:83]
    s_waitcnt lgkmcnt(8)
    ds_read_b64_tr_b16 a[32:33], v18 offset:24832
    ds_read_b64_tr_b16 a[34:35], v18 offset:26368
    v_mfma_f32_16x16x32_bf16 v[88:91], a[8:11], a[84:87], v[88:91]
    v_mfma_f32_16x16x32_bf16 v[84:87], a[12:15], a[80:83], v[84:87]
    s_waitcnt lgkmcnt(8)
    ds_read_b64_tr_b16 a[36:37], v19 offset:24832
    ds_read_b64_tr_b16 a[38:39], v19 offset:26368
    v_mfma_f32_16x16x32_bf16 v[92:95], a[12:15], a[84:87], v[92:95]
    s_add_u32 m0, s12, 73728
    s_add_u32 s67, s21, 4718592
    buffer_load_dwordx4 v2, s[44:47], s67 offen offset:0  lds
    v_mfma_f32_16x16x32_bf16 v[96:99], a[16:19], a[80:83], v[96:99]
    s_waitcnt lgkmcnt(8)
    ds_read_b64_tr_b16 a[40:41], v20 offset:24832
    ds_read_b64_tr_b16 a[42:43], v20 offset:26368
    v_mfma_f32_16x16x32_bf16 v[104:107], a[16:19], a[84:87], v[104:107]
    v_mfma_f32_16x16x32_bf16 v[100:103], a[20:23], a[80:83], v[100:103]
    s_waitcnt lgkmcnt(8)
    ds_read_b64_tr_b16 a[44:45], v21 offset:24832
    ds_read_b64_tr_b16 a[46:47], v21 offset:26368
    v_mfma_f32_16x16x32_bf16 v[108:111], a[20:23], a[84:87], v[108:111]
    buffer_load_dwordx4 v3, s[44:47], s67 offen offset:1024  lds
    v_mfma_f32_16x16x32_bf16 v[112:115], a[24:27], a[80:83], v[112:115]
    s_waitcnt lgkmcnt(8)
    ds_read_b64_tr_b16 a[0:1], v18 offset:36864
    ds_read_b64_tr_b16 a[2:3], v18 offset:38400
    v_mfma_f32_16x16x32_bf16 v[120:123], a[24:27], a[84:87], v[120:123]
    v_mfma_f32_16x16x32_bf16 v[116:119], a[28:31], a[80:83], v[116:119]
    s_waitcnt lgkmcnt(8)
    ds_read_b64_tr_b16 a[4:5], v19 offset:36864
    ds_read_b64_tr_b16 a[6:7], v19 offset:38400
    v_mfma_f32_16x16x32_bf16 v[124:127], a[28:31], a[84:87], v[124:127]
    v_mfma_f32_16x16x32_bf16 v[128:131], a[32:35], a[80:83], v[128:131]
    s_waitcnt lgkmcnt(8)
    ds_read_b64_tr_b16 a[8:9], v20 offset:36864
    ds_read_b64_tr_b16 a[10:11], v20 offset:38400
    v_mfma_f32_16x16x32_bf16 v[136:139], a[32:35], a[84:87], v[136:139]
    buffer_load_dwordx4 v4, s[44:47], s67 offen offset:2048  lds
    v_mfma_f32_16x16x32_bf16 v[132:135], a[36:39], a[80:83], v[132:135]
    s_waitcnt lgkmcnt(8)
    ds_read_b64_tr_b16 a[12:13], v21 offset:36864
    ds_read_b64_tr_b16 a[14:15], v21 offset:38400
    v_mfma_f32_16x16x32_bf16 v[140:143], a[36:39], a[84:87], v[140:143]
    v_mfma_f32_16x16x32_bf16 v[144:147], a[40:43], a[80:83], v[144:147]
    s_waitcnt lgkmcnt(8)
    ds_read_b64_tr_b16 a[16:17], v18 offset:36992
    ds_read_b64_tr_b16 a[18:19], v18 offset:38528
    v_mfma_f32_16x16x32_bf16 v[152:155], a[40:43], a[84:87], v[152:155]
    v_mfma_f32_16x16x32_bf16 v[148:151], a[44:47], a[80:83], v[148:151]
    s_waitcnt lgkmcnt(8)
    ds_read_b64_tr_b16 a[20:21], v19 offset:36992
    ds_read_b64_tr_b16 a[22:23], v19 offset:38528
    v_mfma_f32_16x16x32_bf16 v[156:159], a[44:47], a[84:87], v[156:159]
    s_add_u32 m0, s12, 76800
    s_nop 0
    buffer_load_dwordx4 v5, s[44:47], s67 offen offset:0  lds
    v_mfma_f32_16x16x32_bf16 v[64:67], a[0:3], a[88:91], v[64:67]
    s_waitcnt lgkmcnt(8)
    ds_read_b64_tr_b16 a[24:25], v20 offset:36992
    ds_read_b64_tr_b16 a[26:27], v20 offset:38528
    v_mfma_f32_16x16x32_bf16 v[72:75], a[0:3], a[92:95], v[72:75]
    v_mfma_f32_16x16x32_bf16 v[68:71], a[4:7], a[88:91], v[68:71]
    s_waitcnt lgkmcnt(8)
    ds_read_b64_tr_b16 a[28:29], v21 offset:36992
    ds_read_b64_tr_b16 a[30:31], v21 offset:38528
    v_mfma_f32_16x16x32_bf16 v[76:79], a[4:7], a[92:95], v[76:79]
    v_mfma_f32_16x16x32_bf16 v[80:83], a[8:11], a[88:91], v[80:83]
    s_waitcnt lgkmcnt(8)
    ds_read_b64_tr_b16 a[32:33], v18 offset:37120
    ds_read_b64_tr_b16 a[34:35], v18 offset:38656
    v_mfma_f32_16x16x32_bf16 v[88:91], a[8:11], a[92:95], v[88:91]
    buffer_load_dwordx4 v6, s[44:47], s67 offen offset:1024  lds
    v_mfma_f32_16x16x32_bf16 v[84:87], a[12:15], a[88:91], v[84:87]
    s_waitcnt lgkmcnt(8)
    ds_read_b64_tr_b16 a[36:37], v19 offset:37120
    ds_read_b64_tr_b16 a[38:39], v19 offset:38656
    v_mfma_f32_16x16x32_bf16 v[92:95], a[12:15], a[92:95], v[92:95]
    v_mfma_f32_16x16x32_bf16 v[96:99], a[16:19], a[88:91], v[96:99]
    s_waitcnt lgkmcnt(8)
    ds_read_b64_tr_b16 a[40:41], v20 offset:37120
    ds_read_b64_tr_b16 a[42:43], v20 offset:38656
    v_mfma_f32_16x16x32_bf16 v[104:107], a[16:19], a[92:95], v[104:107]
    v_mfma_f32_16x16x32_bf16 v[100:103], a[20:23], a[88:91], v[100:103]
    s_waitcnt lgkmcnt(8)
    ds_read_b64_tr_b16 a[44:45], v21 offset:37120
    ds_read_b64_tr_b16 a[46:47], v21 offset:38656
    v_mfma_f32_16x16x32_bf16 v[108:111], a[20:23], a[92:95], v[108:111]
    buffer_load_dwordx4 v7, s[44:47], s67 offen offset:2048  lds
    v_mfma_f32_16x16x32_bf16 v[112:115], a[24:27], a[88:91], v[112:115]
    s_waitcnt vmcnt(10)
    s_barrier
    s_waitcnt lgkmcnt(8)
    ds_read_b128 a[64:67], v16 offset:0
    ds_read_b128 a[68:71], v16 offset:2048
    v_mfma_f32_16x16x32_bf16 v[120:123], a[24:27], a[92:95], v[120:123]
    ds_read_b128 a[72:75], v17 offset:0
    v_mfma_f32_16x16x32_bf16 v[116:119], a[28:31], a[88:91], v[116:119]
    s_waitcnt lgkmcnt(9)
    ds_read_b128 a[76:79], v17 offset:2048
    ds_read_b64_tr_b16 a[0:1], v22 offset:0
    v_mfma_f32_16x16x32_bf16 v[124:127], a[28:31], a[92:95], v[124:127]
    ds_read_b64_tr_b16 a[2:3], v22 offset:1536
    s_load_dword s16, s[60:61], 0
    v_mfma_f32_16x16x32_bf16 v[128:131], a[32:35], a[88:91], v[128:131]
    s_waitcnt lgkmcnt(10)
    ds_read_b64_tr_b16 a[4:5], v23 offset:0
    ds_read_b64_tr_b16 a[6:7], v23 offset:1536
    v_mfma_f32_16x16x32_bf16 v[136:139], a[32:35], a[92:95], v[136:139]
    ds_read_b64_tr_b16 a[8:9], v30 offset:0
    v_mfma_f32_16x16x32_bf16 v[132:135], a[36:39], a[88:91], v[132:135]
    s_waitcnt lgkmcnt(11)
    ds_read_b64_tr_b16 a[10:11], v30 offset:1536
    ds_read_b64_tr_b16 a[12:13], v31 offset:0
    v_mfma_f32_16x16x32_bf16 v[140:143], a[36:39], a[92:95], v[140:143]
    ds_read_b64_tr_b16 a[14:15], v31 offset:1536
    s_add_u32 m0, s8, 8192
    s_add_u32 s64, s28, 768
    buffer_load_dwordx4 v8, s[32:35], s64 offen offset:0  lds
    v_mfma_f32_16x16x32_bf16 v[144:147], a[40:43], a[88:91], v[144:147]
    s_waitcnt lgkmcnt(12)
    ds_read_b64_tr_b16 a[16:17], v22 offset:128
    ds_read_b64_tr_b16 a[18:19], v22 offset:1664
    v_mfma_f32_16x16x32_bf16 v[152:155], a[40:43], a[92:95], v[152:155]
    ds_read_b64_tr_b16 a[20:21], v23 offset:128
    v_mfma_f32_16x16x32_bf16 v[148:151], a[44:47], a[88:91], v[148:151]
    s_waitcnt lgkmcnt(9)
    ds_read_b64_tr_b16 a[22:23], v23 offset:1664
    v_mfma_f32_16x16x32_bf16 v[156:159], a[44:47], a[92:95], v[156:159]
    buffer_load_dwordx4 v9, s[32:35], s64 offen offset:1024  lds
    v_mfma_f32_16x16x32_bf16 v[64:67], a[0:3], a[64:67], v[64:67]
    s_waitcnt lgkmcnt(8)
    ds_read_b64_tr_b16 a[24:25], v30 offset:128
    ds_read_b64_tr_b16 a[26:27], v30 offset:1664
    v_mfma_f32_16x16x32_bf16 v[72:75], a[0:3], a[68:71], v[72:75]
    v_mfma_f32_16x16x32_bf16 v[68:71], a[4:7], a[64:67], v[68:71]
    s_waitcnt lgkmcnt(8)
    ds_read_b64_tr_b16 a[28:29], v31 offset:128
    ds_read_b64_tr_b16 a[30:31], v31 offset:1664
    v_mfma_f32_16x16x32_bf16 v[76:79], a[4:7], a[68:71], v[76:79]
    buffer_load_dwordx4 v10, s[32:35], s64 offen offset:2048  lds
    v_mfma_f32_16x16x32_bf16 v[80:83], a[8:11], a[64:67], v[80:83]
    s_waitcnt lgkmcnt(8)
    ds_read_b64_tr_b16 a[32:33], v22 offset:256
    ds_read_b64_tr_b16 a[34:35], v22 offset:1792
    v_mfma_f32_16x16x32_bf16 v[88:91], a[8:11], a[68:71], v[88:91]
    v_mfma_f32_16x16x32_bf16 v[84:87], a[12:15], a[64:67], v[84:87]
    s_waitcnt lgkmcnt(8)
    ds_read_b64_tr_b16 a[36:37], v23 offset:256
    ds_read_b64_tr_b16 a[38:39], v23 offset:1792
    v_mfma_f32_16x16x32_bf16 v[92:95], a[12:15], a[68:71], v[92:95]
    buffer_load_dwordx4 v11, s[32:35], s64 offen offset:3072  lds
    v_mfma_f32_16x16x32_bf16 v[96:99], a[16:19], a[64:67], v[96:99]
    s_waitcnt lgkmcnt(8)
    ds_read_b64_tr_b16 a[40:41], v30 offset:256
    ds_read_b64_tr_b16 a[42:43], v30 offset:1792
    v_mfma_f32_16x16x32_bf16 v[104:107], a[16:19], a[68:71], v[104:107]
    v_mfma_f32_16x16x32_bf16 v[100:103], a[20:23], a[64:67], v[100:103]
    s_waitcnt lgkmcnt(8)
    ds_read_b64_tr_b16 a[44:45], v31 offset:256
    ds_read_b64_tr_b16 a[46:47], v31 offset:1792
    v_mfma_f32_16x16x32_bf16 v[108:111], a[20:23], a[68:71], v[108:111]
    s_add_u32 m0, s12, 0
    s_add_u32 s65, s22, 4718592
    buffer_load_dwordx4 v2, s[44:47], s65 offen offset:0  lds
    v_mfma_f32_16x16x32_bf16 v[112:115], a[24:27], a[64:67], v[112:115]
    s_waitcnt lgkmcnt(8)
    ds_read_b64_tr_b16 a[0:1], v22 offset:12288
    ds_read_b64_tr_b16 a[2:3], v22 offset:13824
    v_mfma_f32_16x16x32_bf16 v[120:123], a[24:27], a[68:71], v[120:123]
    v_mfma_f32_16x16x32_bf16 v[116:119], a[28:31], a[64:67], v[116:119]
    s_waitcnt lgkmcnt(8)
    ds_read_b64_tr_b16 a[4:5], v23 offset:12288
    ds_read_b64_tr_b16 a[6:7], v23 offset:13824
    v_mfma_f32_16x16x32_bf16 v[124:127], a[28:31], a[68:71], v[124:127]
    buffer_load_dwordx4 v3, s[44:47], s65 offen offset:1024  lds
    v_mfma_f32_16x16x32_bf16 v[128:131], a[32:35], a[64:67], v[128:131]
    s_waitcnt lgkmcnt(8)
    ds_read_b64_tr_b16 a[8:9], v30 offset:12288
    ds_read_b64_tr_b16 a[10:11], v30 offset:13824
    v_mfma_f32_16x16x32_bf16 v[136:139], a[32:35], a[68:71], v[136:139]
    v_mfma_f32_16x16x32_bf16 v[132:135], a[36:39], a[64:67], v[132:135]
    s_waitcnt lgkmcnt(8)
    ds_read_b64_tr_b16 a[12:13], v31 offset:12288
    ds_read_b64_tr_b16 a[14:15], v31 offset:13824
    v_mfma_f32_16x16x32_bf16 v[140:143], a[36:39], a[68:71], v[140:143]
    buffer_load_dwordx4 v4, s[44:47], s65 offen offset:2048  lds
    v_mfma_f32_16x16x32_bf16 v[144:147], a[40:43], a[64:67], v[144:147]
    s_waitcnt lgkmcnt(8)
    ds_read_b64_tr_b16 a[16:17], v22 offset:12416
    ds_read_b64_tr_b16 a[18:19], v22 offset:13952
    v_mfma_f32_16x16x32_bf16 v[152:155], a[40:43], a[68:71], v[152:155]
    v_mfma_f32_16x16x32_bf16 v[148:151], a[44:47], a[64:67], v[148:151]
    s_waitcnt lgkmcnt(8)
    ds_read_b64_tr_b16 a[20:21], v23 offset:12416
    ds_read_b64_tr_b16 a[22:23], v23 offset:13952
    v_mfma_f32_16x16x32_bf16 v[156:159], a[44:47], a[68:71], v[156:159]
    s_add_u32 m0, s12, 3072
    s_nop 0
    buffer_load_dwordx4 v5, s[44:47], s65 offen offset:0  lds
    v_mfma_f32_16x16x32_bf16 v[64:67], a[0:3], a[72:75], v[64:67]
    s_waitcnt lgkmcnt(8)
    ds_read_b64_tr_b16 a[24:25], v30 offset:12416
    ds_read_b64_tr_b16 a[26:27], v30 offset:13952
    v_mfma_f32_16x16x32_bf16 v[72:75], a[0:3], a[76:79], v[72:75]
    v_mfma_f32_16x16x32_bf16 v[68:71], a[4:7], a[72:75], v[68:71]
    s_waitcnt lgkmcnt(8)
    ds_read_b64_tr_b16 a[28:29], v31 offset:12416
    ds_read_b64_tr_b16 a[30:31], v31 offset:13952
    v_mfma_f32_16x16x32_bf16 v[76:79], a[4:7], a[76:79], v[76:79]
    v_mfma_f32_16x16x32_bf16 v[80:83], a[8:11], a[72:75], v[80:83]
    s_waitcnt lgkmcnt(8)
    ds_read_b64_tr_b16 a[32:33], v22 offset:12544
    ds_read_b64_tr_b16 a[34:35], v22 offset:14080
    v_mfma_f32_16x16x32_bf16 v[88:91], a[8:11], a[76:79], v[88:91]
    buffer_load_dwordx4 v6, s[44:47], s65 offen offset:1024  lds
    v_mfma_f32_16x16x32_bf16 v[84:87], a[12:15], a[72:75], v[84:87]
    s_waitcnt lgkmcnt(8)
    ds_read_b64_tr_b16 a[36:37], v23 offset:12544
    ds_read_b64_tr_b16 a[38:39], v23 offset:14080
    v_mfma_f32_16x16x32_bf16 v[92:95], a[12:15], a[76:79], v[92:95]
    v_mfma_f32_16x16x32_bf16 v[96:99], a[16:19], a[72:75], v[96:99]
    s_waitcnt lgkmcnt(8)
    ds_read_b64_tr_b16 a[40:41], v30 offset:12544
    ds_read_b64_tr_b16 a[42:43], v30 offset:14080
    v_mfma_f32_16x16x32_bf16 v[104:107], a[16:19], a[76:79], v[104:107]
    v_mfma_f32_16x16x32_bf16 v[100:103], a[20:23], a[72:75], v[100:103]
    s_waitcnt lgkmcnt(8)
    ds_read_b64_tr_b16 a[44:45], v31 offset:12544
    ds_read_b64_tr_b16 a[46:47], v31 offset:14080
    v_mfma_f32_16x16x32_bf16 v[108:111], a[20:23], a[76:79], v[108:111]
    buffer_load_dwordx4 v7, s[44:47], s65 offen offset:2048  lds
    v_mfma_f32_16x16x32_bf16 v[112:115], a[24:27], a[72:75], v[112:115]
    s_waitcnt vmcnt(10)
    s_barrier
    s_waitcnt lgkmcnt(8)
    ds_read_b128 a[80:83], v16 offset:4096
    ds_read_b128 a[84:87], v16 offset:6144
    v_mfma_f32_16x16x32_bf16 v[120:123], a[24:27], a[76:79], v[120:123]
    ds_read_b128 a[88:91], v17 offset:4096
    v_mfma_f32_16x16x32_bf16 v[116:119], a[28:31], a[72:75], v[116:119]
    s_waitcnt lgkmcnt(9)
    ds_read_b128 a[92:95], v17 offset:6144
    ds_read_b64_tr_b16 a[0:1], v22 offset:24576
    v_mfma_f32_16x16x32_bf16 v[124:127], a[28:31], a[76:79], v[124:127]
    ds_read_b64_tr_b16 a[2:3], v22 offset:26112
    s_add_u32 m0, s8, 0
    s_add_u32 s66, s29, 768
    buffer_load_dwordx4 v8, s[32:35], s66 offen offset:0  lds
    v_mfma_f32_16x16x32_bf16 v[128:131], a[32:35], a[72:75], v[128:131]
    s_waitcnt lgkmcnt(10)
    ds_read_b64_tr_b16 a[4:5], v23 offset:24576
    ds_read_b64_tr_b16 a[6:7], v23 offset:26112
    v_mfma_f32_16x16x32_bf16 v[136:139], a[32:35], a[76:79], v[136:139]
    ds_read_b64_tr_b16 a[8:9], v30 offset:24576
    buffer_load_dwordx4 v9, s[32:35], s66 offen offset:1024  lds
    v_mfma_f32_16x16x32_bf16 v[132:135], a[36:39], a[72:75], v[132:135]
    s_waitcnt lgkmcnt(11)
    ds_read_b64_tr_b16 a[10:11], v30 offset:26112
    ds_read_b64_tr_b16 a[12:13], v31 offset:24576
    v_mfma_f32_16x16x32_bf16 v[140:143], a[36:39], a[76:79], v[140:143]
    ds_read_b64_tr_b16 a[14:15], v31 offset:26112
    v_mfma_f32_16x16x32_bf16 v[144:147], a[40:43], a[72:75], v[144:147]
    s_waitcnt lgkmcnt(12)
    ds_read_b64_tr_b16 a[16:17], v22 offset:24704
    ds_read_b64_tr_b16 a[18:19], v22 offset:26240
    v_mfma_f32_16x16x32_bf16 v[152:155], a[40:43], a[76:79], v[152:155]
    ds_read_b64_tr_b16 a[20:21], v23 offset:24704
    buffer_load_dwordx4 v10, s[32:35], s66 offen offset:2048  lds
    v_mfma_f32_16x16x32_bf16 v[148:151], a[44:47], a[72:75], v[148:151]
    s_waitcnt lgkmcnt(9)
    ds_read_b64_tr_b16 a[22:23], v23 offset:26240
    v_mfma_f32_16x16x32_bf16 v[156:159], a[44:47], a[76:79], v[156:159]
    buffer_load_dwordx4 v11, s[32:35], s66 offen offset:3072  lds
    v_mfma_f32_16x16x32_bf16 v[64:67], a[0:3], a[80:83], v[64:67]
    s_waitcnt lgkmcnt(8)
    ds_read_b64_tr_b16 a[24:25], v30 offset:24704
    ds_read_b64_tr_b16 a[26:27], v30 offset:26240
    v_mfma_f32_16x16x32_bf16 v[72:75], a[0:3], a[84:87], v[72:75]
    v_mfma_f32_16x16x32_bf16 v[68:71], a[4:7], a[80:83], v[68:71]
    s_waitcnt lgkmcnt(8)
    ds_read_b64_tr_b16 a[28:29], v31 offset:24704
    ds_read_b64_tr_b16 a[30:31], v31 offset:26240
    v_mfma_f32_16x16x32_bf16 v[76:79], a[4:7], a[84:87], v[76:79]
    s_add_u32 m0, s12, 24576
    s_add_u32 s67, s23, 4718592
    buffer_load_dwordx4 v2, s[44:47], s67 offen offset:0  lds
    v_mfma_f32_16x16x32_bf16 v[80:83], a[8:11], a[80:83], v[80:83]
    s_waitcnt lgkmcnt(8)
    ds_read_b64_tr_b16 a[32:33], v22 offset:24832
    ds_read_b64_tr_b16 a[34:35], v22 offset:26368
    v_mfma_f32_16x16x32_bf16 v[88:91], a[8:11], a[84:87], v[88:91]
    buffer_load_dwordx4 v3, s[44:47], s67 offen offset:1024  lds
    v_mfma_f32_16x16x32_bf16 v[84:87], a[12:15], a[80:83], v[84:87]
    s_waitcnt lgkmcnt(8)
    ds_read_b64_tr_b16 a[36:37], v23 offset:24832
    ds_read_b64_tr_b16 a[38:39], v23 offset:26368
    v_mfma_f32_16x16x32_bf16 v[92:95], a[12:15], a[84:87], v[92:95]
    v_mfma_f32_16x16x32_bf16 v[96:99], a[16:19], a[80:83], v[96:99]
    s_waitcnt lgkmcnt(8)
    ds_read_b64_tr_b16 a[40:41], v30 offset:24832
    ds_read_b64_tr_b16 a[42:43], v30 offset:26368
    v_mfma_f32_16x16x32_bf16 v[104:107], a[16:19], a[84:87], v[104:107]
    buffer_load_dwordx4 v4, s[44:47], s67 offen offset:2048  lds
    v_mfma_f32_16x16x32_bf16 v[100:103], a[20:23], a[80:83], v[100:103]
    s_waitcnt lgkmcnt(8)
    ds_read_b64_tr_b16 a[44:45], v31 offset:24832
    ds_read_b64_tr_b16 a[46:47], v31 offset:26368
    v_mfma_f32_16x16x32_bf16 v[108:111], a[20:23], a[84:87], v[108:111]
    s_add_u32 m0, s12, 27648
    s_nop 0
    buffer_load_dwordx4 v5, s[44:47], s67 offen offset:0  lds
    v_mfma_f32_16x16x32_bf16 v[112:115], a[24:27], a[80:83], v[112:115]
    s_waitcnt lgkmcnt(8)
    ds_read_b64_tr_b16 a[0:1], v22 offset:36864
    ds_read_b64_tr_b16 a[2:3], v22 offset:38400
    v_mfma_f32_16x16x32_bf16 v[120:123], a[24:27], a[84:87], v[120:123]
    v_mfma_f32_16x16x32_bf16 v[116:119], a[28:31], a[80:83], v[116:119]
    s_waitcnt lgkmcnt(8)
    ds_read_b64_tr_b16 a[4:5], v23 offset:36864
    ds_read_b64_tr_b16 a[6:7], v23 offset:38400
    v_mfma_f32_16x16x32_bf16 v[124:127], a[28:31], a[84:87], v[124:127]
    buffer_load_dwordx4 v6, s[44:47], s67 offen offset:1024  lds
    v_mfma_f32_16x16x32_bf16 v[128:131], a[32:35], a[80:83], v[128:131]
    s_waitcnt lgkmcnt(8)
    ds_read_b64_tr_b16 a[8:9], v30 offset:36864
    ds_read_b64_tr_b16 a[10:11], v30 offset:38400
    v_mfma_f32_16x16x32_bf16 v[136:139], a[32:35], a[84:87], v[136:139]
    v_mfma_f32_16x16x32_bf16 v[132:135], a[36:39], a[80:83], v[132:135]
    s_waitcnt lgkmcnt(8)
    ds_read_b64_tr_b16 a[12:13], v31 offset:36864
    ds_read_b64_tr_b16 a[14:15], v31 offset:38400
    v_mfma_f32_16x16x32_bf16 v[140:143], a[36:39], a[84:87], v[140:143]
    buffer_load_dwordx4 v7, s[44:47], s67 offen offset:2048  lds
    v_mfma_f32_16x16x32_bf16 v[144:147], a[40:43], a[80:83], v[144:147]
    s_waitcnt lgkmcnt(8)
    ds_read_b64_tr_b16 a[16:17], v22 offset:36992
    ds_read_b64_tr_b16 a[18:19], v22 offset:38528
    v_mfma_f32_16x16x32_bf16 v[152:155], a[40:43], a[84:87], v[152:155]
    v_mfma_f32_16x16x32_bf16 v[148:151], a[44:47], a[80:83], v[148:151]
    s_waitcnt lgkmcnt(8)
    ds_read_b64_tr_b16 a[20:21], v23 offset:36992
    ds_read_b64_tr_b16 a[22:23], v23 offset:38528
    v_mfma_f32_16x16x32_bf16 v[156:159], a[44:47], a[84:87], v[156:159]
    s_add_u32 m0, s8, 12288
    s_add_u32 s64, s11, 128
    buffer_load_dwordx4 v12, s[36:39], s64 offen offset:0  lds
    v_mfma_f32_16x16x32_bf16 v[64:67], a[0:3], a[88:91], v[64:67]
    s_waitcnt lgkmcnt(8)
    ds_read_b64_tr_b16 a[24:25], v30 offset:36992
    ds_read_b64_tr_b16 a[26:27], v30 offset:38528
    v_mfma_f32_16x16x32_bf16 v[72:75], a[0:3], a[92:95], v[72:75]
    v_mfma_f32_16x16x32_bf16 v[68:71], a[4:7], a[88:91], v[68:71]
    s_waitcnt lgkmcnt(8)
    ds_read_b64_tr_b16 a[28:29], v31 offset:36992
    ds_read_b64_tr_b16 a[30:31], v31 offset:38528
    v_mfma_f32_16x16x32_bf16 v[76:79], a[4:7], a[92:95], v[76:79]
    buffer_load_dwordx4 v13, s[36:39], s64 offen offset:1024  lds
    v_mfma_f32_16x16x32_bf16 v[80:83], a[8:11], a[88:91], v[80:83]
    s_waitcnt lgkmcnt(8)
    ds_read_b64_tr_b16 a[32:33], v22 offset:37120
    ds_read_b64_tr_b16 a[34:35], v22 offset:38656
    v_mfma_f32_16x16x32_bf16 v[88:91], a[8:11], a[92:95], v[88:91]
    v_mfma_f32_16x16x32_bf16 v[84:87], a[12:15], a[88:91], v[84:87]
    s_waitcnt lgkmcnt(8)
    ds_read_b64_tr_b16 a[36:37], v23 offset:37120
    ds_read_b64_tr_b16 a[38:39], v23 offset:38656
    v_mfma_f32_16x16x32_bf16 v[92:95], a[12:15], a[92:95], v[92:95]
    buffer_load_dwordx4 v14, s[36:39], s64 offen offset:2048  lds
    v_mfma_f32_16x16x32_bf16 v[96:99], a[16:19], a[88:91], v[96:99]
    s_waitcnt lgkmcnt(8)
    ds_read_b64_tr_b16 a[40:41], v30 offset:37120
    ds_read_b64_tr_b16 a[42:43], v30 offset:38656
    v_mfma_f32_16x16x32_bf16 v[104:107], a[16:19], a[92:95], v[104:107]
    v_mfma_f32_16x16x32_bf16 v[100:103], a[20:23], a[88:91], v[100:103]
    s_waitcnt lgkmcnt(8)
    ds_read_b64_tr_b16 a[44:45], v31 offset:37120
    ds_read_b64_tr_b16 a[46:47], v31 offset:38656
    v_mfma_f32_16x16x32_bf16 v[108:111], a[20:23], a[92:95], v[108:111]
    buffer_load_dwordx4 v15, s[36:39], s64 offen offset:3072  lds
    v_mfma_f32_16x16x32_bf16 v[112:115], a[24:27], a[88:91], v[112:115]
    s_waitcnt vmcnt(14)
    s_barrier
    s_waitcnt lgkmcnt(8)
    ds_read_b128 a[64:67], v16 offset:8192
    ds_read_b128 a[68:71], v16 offset:10240
    v_mfma_f32_16x16x32_bf16 v[120:123], a[24:27], a[92:95], v[120:123]
    ds_read_b128 a[72:75], v17 offset:8192
    v_mfma_f32_16x16x32_bf16 v[116:119], a[28:31], a[88:91], v[116:119]
    s_waitcnt lgkmcnt(9)
    ds_read_b128 a[76:79], v17 offset:10240
    ds_read_b64_tr_b16 a[0:1], v18 offset:0
    v_mfma_f32_16x16x32_bf16 v[124:127], a[28:31], a[92:95], v[124:127]
    ds_read_b64_tr_b16 a[2:3], v18 offset:1536
    s_add_u32 m0, s8, 4096
    s_add_u32 s65, s11, 256
    buffer_load_dwordx4 v12, s[36:39], s65 offen offset:0  lds
    v_mfma_f32_16x16x32_bf16 v[128:131], a[32:35], a[88:91], v[128:131]
    s_waitcnt lgkmcnt(10)
    ds_read_b64_tr_b16 a[4:5], v19 offset:0
    ds_read_b64_tr_b16 a[6:7], v19 offset:1536
    v_mfma_f32_16x16x32_bf16 v[136:139], a[32:35], a[92:95], v[136:139]
    ds_read_b64_tr_b16 a[8:9], v20 offset:0
    buffer_load_dwordx4 v13, s[36:39], s65 offen offset:1024  lds
    v_mfma_f32_16x16x32_bf16 v[132:135], a[36:39], a[88:91], v[132:135]
    s_waitcnt lgkmcnt(11)
    ds_read_b64_tr_b16 a[10:11], v20 offset:1536
    ds_read_b64_tr_b16 a[12:13], v21 offset:0
    v_mfma_f32_16x16x32_bf16 v[140:143], a[36:39], a[92:95], v[140:143]
    ds_read_b64_tr_b16 a[14:15], v21 offset:1536
    buffer_load_dwordx4 v14, s[36:39], s65 offen offset:2048  lds
    v_mfma_f32_16x16x32_bf16 v[144:147], a[40:43], a[88:91], v[144:147]
    s_waitcnt lgkmcnt(12)
    ds_read_b64_tr_b16 a[16:17], v18 offset:128
    ds_read_b64_tr_b16 a[18:19], v18 offset:1664
    v_mfma_f32_16x16x32_bf16 v[152:155], a[40:43], a[92:95], v[152:155]
    ds_read_b64_tr_b16 a[20:21], v19 offset:128
    buffer_load_dwordx4 v15, s[36:39], s65 offen offset:3072  lds
    v_mfma_f32_16x16x32_bf16 v[148:151], a[44:47], a[88:91], v[148:151]
    s_waitcnt lgkmcnt(9)
    ds_read_b64_tr_b16 a[22:23], v19 offset:1664
    v_mfma_f32_16x16x32_bf16 v[156:159], a[44:47], a[92:95], v[156:159]
    v_lshlrev_b32 v25, 7, v1
    s_mov_b64 exec, 0xffffff
    buffer_load_dword a255, v25, s[56:59], s40 offen
    s_mov_b64 exec, -1
    v_mfma_f32_16x16x32_bf16 v[64:67], a[0:3], a[64:67], v[64:67]
    s_waitcnt lgkmcnt(8)
    ds_read_b64_tr_b16 a[24:25], v20 offset:128
    ds_read_b64_tr_b16 a[26:27], v20 offset:1664
    v_mfma_f32_16x16x32_bf16 v[72:75], a[0:3], a[68:71], v[72:75]
    v_mfma_f32_16x16x32_bf16 v[68:71], a[4:7], a[64:67], v[68:71]
    s_waitcnt lgkmcnt(8)
    ds_read_b64_tr_b16 a[28:29], v21 offset:128
    ds_read_b64_tr_b16 a[30:31], v21 offset:1664
    v_mfma_f32_16x16x32_bf16 v[76:79], a[4:7], a[68:71], v[76:79]
    v_mfma_f32_16x16x32_bf16 v[80:83], a[8:11], a[64:67], v[80:83]
    s_waitcnt lgkmcnt(8)
    ds_read_b64_tr_b16 a[32:33], v18 offset:256
    ds_read_b64_tr_b16 a[34:35], v18 offset:1792
    v_mfma_f32_16x16x32_bf16 v[88:91], a[8:11], a[68:71], v[88:91]
    v_mfma_f32_16x16x32_bf16 v[84:87], a[12:15], a[64:67], v[84:87]
    s_waitcnt lgkmcnt(8)
    ds_read_b64_tr_b16 a[36:37], v19 offset:256
    ds_read_b64_tr_b16 a[38:39], v19 offset:1792
    v_mfma_f32_16x16x32_bf16 v[92:95], a[12:15], a[68:71], v[92:95]
    v_mfma_f32_16x16x32_bf16 v[96:99], a[16:19], a[64:67], v[96:99]
    s_waitcnt lgkmcnt(8)
    ds_read_b64_tr_b16 a[40:41], v20 offset:256
    ds_read_b64_tr_b16 a[42:43], v20 offset:1792
    v_mfma_f32_16x16x32_bf16 v[104:107], a[16:19], a[68:71], v[104:107]
    v_mfma_f32_16x16x32_bf16 v[100:103], a[20:23], a[64:67], v[100:103]
    s_waitcnt lgkmcnt(8)
    ds_read_b64_tr_b16 a[44:45], v21 offset:256
    ds_read_b64_tr_b16 a[46:47], v21 offset:1792
    v_mfma_f32_16x16x32_bf16 v[108:111], a[20:23], a[68:71], v[108:111]
    v_mfma_f32_16x16x32_bf16 v[112:115], a[24:27], a[64:67], v[112:115]
    s_waitcnt lgkmcnt(8)
    ds_read_b64_tr_b16 a[0:1], v18 offset:12288
    ds_read_b64_tr_b16 a[2:3], v18 offset:13824
    v_mfma_f32_16x16x32_bf16 v[120:123], a[24:27], a[68:71], v[120:123]
    v_mfma_f32_16x16x32_bf16 v[116:119], a[28:31], a[64:67], v[116:119]
    s_waitcnt lgkmcnt(8)
    ds_read_b64_tr_b16 a[4:5], v19 offset:12288
    ds_read_b64_tr_b16 a[6:7], v19 offset:13824
    v_mfma_f32_16x16x32_bf16 v[124:127], a[28:31], a[68:71], v[124:127]
    v_mfma_f32_16x16x32_bf16 v[128:131], a[32:35], a[64:67], v[128:131]
    s_waitcnt lgkmcnt(8)
    ds_read_b64_tr_b16 a[8:9], v20 offset:12288
    ds_read_b64_tr_b16 a[10:11], v20 offset:13824
    v_mfma_f32_16x16x32_bf16 v[136:139], a[32:35], a[68:71], v[136:139]
    v_mfma_f32_16x16x32_bf16 v[132:135], a[36:39], a[64:67], v[132:135]
    s_waitcnt lgkmcnt(8)
    ds_read_b64_tr_b16 a[12:13], v21 offset:12288
    ds_read_b64_tr_b16 a[14:15], v21 offset:13824
    v_mfma_f32_16x16x32_bf16 v[140:143], a[36:39], a[68:71], v[140:143]
    v_mfma_f32_16x16x32_bf16 v[144:147], a[40:43], a[64:67], v[144:147]
    s_waitcnt lgkmcnt(8)
    ds_read_b64_tr_b16 a[16:17], v18 offset:12416
    ds_read_b64_tr_b16 a[18:19], v18 offset:13952
    v_mfma_f32_16x16x32_bf16 v[152:155], a[40:43], a[68:71], v[152:155]
    v_mfma_f32_16x16x32_bf16 v[148:151], a[44:47], a[64:67], v[148:151]
    s_waitcnt lgkmcnt(8)
    ds_read_b64_tr_b16 a[20:21], v19 offset:12416
    ds_read_b64_tr_b16 a[22:23], v19 offset:13952
    v_mfma_f32_16x16x32_bf16 v[156:159], a[44:47], a[68:71], v[156:159]
    v_mfma_f32_16x16x32_bf16 v[64:67], a[0:3], a[72:75], v[64:67]
    s_waitcnt lgkmcnt(8)
    ds_read_b64_tr_b16 a[24:25], v20 offset:12416
    ds_read_b64_tr_b16 a[26:27], v20 offset:13952
    v_mfma_f32_16x16x32_bf16 v[72:75], a[0:3], a[76:79], v[72:75]
    v_mfma_f32_16x16x32_bf16 v[68:71], a[4:7], a[72:75], v[68:71]
    s_waitcnt lgkmcnt(8)
    ds_read_b64_tr_b16 a[28:29], v21 offset:12416
    ds_read_b64_tr_b16 a[30:31], v21 offset:13952
    v_mfma_f32_16x16x32_bf16 v[76:79], a[4:7], a[76:79], v[76:79]
    v_mfma_f32_16x16x32_bf16 v[80:83], a[8:11], a[72:75], v[80:83]
    s_waitcnt lgkmcnt(8)
    ds_read_b64_tr_b16 a[32:33], v18 offset:12544
    ds_read_b64_tr_b16 a[34:35], v18 offset:14080
    v_mfma_f32_16x16x32_bf16 v[88:91], a[8:11], a[76:79], v[88:91]
    v_mfma_f32_16x16x32_bf16 v[84:87], a[12:15], a[72:75], v[84:87]
    s_waitcnt lgkmcnt(8)
    ds_read_b64_tr_b16 a[36:37], v19 offset:12544
    ds_read_b64_tr_b16 a[38:39], v19 offset:14080
    v_mfma_f32_16x16x32_bf16 v[92:95], a[12:15], a[76:79], v[92:95]
    v_mfma_f32_16x16x32_bf16 v[96:99], a[16:19], a[72:75], v[96:99]
    s_waitcnt lgkmcnt(8)
    ds_read_b64_tr_b16 a[40:41], v20 offset:12544
    ds_read_b64_tr_b16 a[42:43], v20 offset:14080
    v_mfma_f32_16x16x32_bf16 v[104:107], a[16:19], a[76:79], v[104:107]
    v_mfma_f32_16x16x32_bf16 v[100:103], a[20:23], a[72:75], v[100:103]
    s_waitcnt lgkmcnt(8)
    ds_read_b64_tr_b16 a[44:45], v21 offset:12544
    ds_read_b64_tr_b16 a[46:47], v21 offset:14080
    v_mfma_f32_16x16x32_bf16 v[108:111], a[20:23], a[76:79], v[108:111]
    v_mfma_f32_16x16x32_bf16 v[112:115], a[24:27], a[72:75], v[112:115]
    s_waitcnt vmcnt(9)
    s_barrier
    s_waitcnt lgkmcnt(8)
    ds_read_b128 a[80:83], v16 offset:0
    ds_read_b128 a[84:87], v16 offset:2048
    v_mfma_f32_16x16x32_bf16 v[120:123], a[24:27], a[76:79], v[120:123]
    ds_read_b128 a[88:91], v17 offset:0
    v_mfma_f32_16x16x32_bf16 v[116:119], a[28:31], a[72:75], v[116:119]
    s_waitcnt lgkmcnt(9)
    ds_read_b128 a[92:95], v17 offset:2048
    ds_read_b64_tr_b16 a[0:1], v18 offset:24576
    v_mfma_f32_16x16x32_bf16 v[124:127], a[28:31], a[76:79], v[124:127]
    ds_read_b64_tr_b16 a[2:3], v18 offset:26112
    v_mfma_f32_16x16x32_bf16 v[128:131], a[32:35], a[72:75], v[128:131]
    s_waitcnt lgkmcnt(10)
    ds_read_b64_tr_b16 a[4:5], v19 offset:24576
    ds_read_b64_tr_b16 a[6:7], v19 offset:26112
    v_mfma_f32_16x16x32_bf16 v[136:139], a[32:35], a[76:79], v[136:139]
    ds_read_b64_tr_b16 a[8:9], v20 offset:24576
    v_mfma_f32_16x16x32_bf16 v[132:135], a[36:39], a[72:75], v[132:135]
    s_waitcnt lgkmcnt(11)
    ds_read_b64_tr_b16 a[10:11], v20 offset:26112
    ds_read_b64_tr_b16 a[12:13], v21 offset:24576
    v_mfma_f32_16x16x32_bf16 v[140:143], a[36:39], a[76:79], v[140:143]
    ds_read_b64_tr_b16 a[14:15], v21 offset:26112
    v_mfma_f32_16x16x32_bf16 v[144:147], a[40:43], a[72:75], v[144:147]
    s_waitcnt lgkmcnt(12)
    ds_read_b64_tr_b16 a[16:17], v18 offset:24704
    ds_read_b64_tr_b16 a[18:19], v18 offset:26240
    v_mfma_f32_16x16x32_bf16 v[152:155], a[40:43], a[76:79], v[152:155]
    ds_read_b64_tr_b16 a[20:21], v19 offset:24704
    v_mfma_f32_16x16x32_bf16 v[148:151], a[44:47], a[72:75], v[148:151]
    s_waitcnt lgkmcnt(9)
    ds_read_b64_tr_b16 a[22:23], v19 offset:26240
    v_mfma_f32_16x16x32_bf16 v[156:159], a[44:47], a[76:79], v[156:159]
    v_mfma_f32_16x16x32_bf16 v[64:67], a[0:3], a[80:83], v[64:67]
    s_waitcnt lgkmcnt(8)
    ds_read_b64_tr_b16 a[24:25], v18 offset:36864
    ds_read_b64_tr_b16 a[26:27], v18 offset:38400
    v_mfma_f32_16x16x32_bf16 v[72:75], a[0:3], a[84:87], v[72:75]
    v_mfma_f32_16x16x32_bf16 v[68:71], a[4:7], a[80:83], v[68:71]
    s_waitcnt lgkmcnt(8)
    ds_read_b64_tr_b16 a[28:29], v19 offset:36864
    ds_read_b64_tr_b16 a[30:31], v19 offset:38400
    v_mfma_f32_16x16x32_bf16 v[76:79], a[4:7], a[84:87], v[76:79]
    v_mfma_f32_16x16x32_bf16 v[80:83], a[8:11], a[80:83], v[80:83]
    s_waitcnt lgkmcnt(8)
    ds_read_b64_tr_b16 a[32:33], v20 offset:36864
    ds_read_b64_tr_b16 a[34:35], v20 offset:38400
    v_mfma_f32_16x16x32_bf16 v[88:91], a[8:11], a[84:87], v[88:91]
    v_mfma_f32_16x16x32_bf16 v[84:87], a[12:15], a[80:83], v[84:87]
    s_waitcnt lgkmcnt(8)
    ds_read_b64_tr_b16 a[36:37], v21 offset:36864
    ds_read_b64_tr_b16 a[38:39], v21 offset:38400
    v_mfma_f32_16x16x32_bf16 v[92:95], a[12:15], a[84:87], v[92:95]
    v_mfma_f32_16x16x32_bf16 v[96:99], a[16:19], a[80:83], v[96:99]
    s_waitcnt lgkmcnt(8)
    ds_read_b64_tr_b16 a[40:41], v18 offset:36992
    ds_read_b64_tr_b16 a[42:43], v18 offset:38528
    v_mfma_f32_16x16x32_bf16 v[104:107], a[16:19], a[84:87], v[104:107]
    v_mfma_f32_16x16x32_bf16 v[100:103], a[20:23], a[80:83], v[100:103]
    s_waitcnt lgkmcnt(8)
    ds_read_b64_tr_b16 a[44:45], v19 offset:36992
    ds_read_b64_tr_b16 a[46:47], v19 offset:38528
    v_mfma_f32_16x16x32_bf16 v[108:111], a[20:23], a[84:87], v[108:111]
    s_waitcnt lgkmcnt(0)
    s_cmp_lg_u32 s16, 0
    s_cbranch_scc1 L_ngA1
    s_mov_b32 s17, 20000
L_ngA0:
    buffer_load_dword v28, v0, s[60:63], 0 offen sc1
    s_waitcnt vmcnt(0)
    v_readfirstlane_b32 s16, v28
    s_nop 0
    s_cmp_lg_u32 s16, 0
    s_cbranch_scc1 L_ngA1
    s_sub_u32 s17, s17, 1
    s_cmp_lg_u32 s17, 0
    s_cbranch_scc1 L_ngA0
L_ngA1:
    s_nop 1
    v_mov_b32 v55, s16
    v_mov_b32 v59, s16
    v_mov_b32 v63, s16
    v_mfma_f32_16x16x32_bf16 v[64:67], a[24:27], a[88:91], v[64:67]
    s_waitcnt lgkmcnt(8)
    ds_read_b64_tr_b16 a[0:1], v20 offset:24704
    ds_read_b64_tr_b16 a[2:3], v20 offset:26240
    v_mfma_f32_16x16x32_bf16 v[72:75], a[24:27], a[92:95], v[72:75]
    v_mfma_f32_16x16x32_bf16 v[68:71], a[28:31], a[88:91], v[68:71]
    s_waitcnt lgkmcnt(8)
    ds_read_b64_tr_b16 a[4:5], v21 offset:24704
    ds_read_b64_tr_b16 a[6:7], v21 offset:26240
    v_mfma_f32_16x16x32_bf16 v[76:79], a[28:31], a[92:95], v[76:79]
    v_mfma_f32_16x16x32_bf16 v[80:83], a[32:35], a[88:91], v[80:83]
    s_waitcnt lgkmcnt(8)
    ds_read_b64_tr_b16 a[8:9], v18 offset:24832
    ds_read_b64_tr_b16 a[10:11], v18 offset:26368
    v_mfma_f32_16x16x32_bf16 v[88:91], a[32:35], a[92:95], v[88:91]
    v_mfma_f32_16x16x32_bf16 v[84:87], a[36:39], a[88:91], v[84:87]
    s_waitcnt lgkmcnt(8)
    ds_read_b64_tr_b16 a[12:13], v19 offset:24832
    ds_read_b64_tr_b16 a[14:15], v19 offset:26368
    v_mfma_f32_16x16x32_bf16 v[92:95], a[36:39], a[92:95], v[92:95]
    v_mfma_f32_16x16x32_bf16 v[96:99], a[40:43], a[88:91], v[96:99]
    s_waitcnt lgkmcnt(8)
    ds_read_b64_tr_b16 a[16:17], v20 offset:24832
    ds_read_b64_tr_b16 a[18:19], v20 offset:26368
    v_mfma_f32_16x16x32_bf16 v[104:107], a[40:43], a[92:95], v[104:107]
    v_mfma_f32_16x16x32_bf16 v[100:103], a[44:47], a[88:91], v[100:103]
    s_waitcnt lgkmcnt(8)
    ds_read_b64_tr_b16 a[20:21], v21 offset:24832
    ds_read_b64_tr_b16 a[22:23], v21 offset:26368
    v_mfma_f32_16x16x32_bf16 v[108:111], a[44:47], a[92:95], v[108:111]
    v_mfma_f32_16x16x32_bf16 v[112:115], a[0:3], a[80:83], v[112:115]
    s_waitcnt lgkmcnt(8)
    ds_read_b64_tr_b16 a[24:25], v20 offset:36992
    ds_read_b64_tr_b16 a[26:27], v20 offset:38528
    v_mfma_f32_16x16x32_bf16 v[120:123], a[0:3], a[84:87], v[120:123]
    v_mfma_f32_16x16x32_bf16 v[116:119], a[4:7], a[80:83], v[116:119]
    s_waitcnt lgkmcnt(8)
    ds_read_b64_tr_b16 a[28:29], v21 offset:36992
    ds_read_b64_tr_b16 a[30:31], v21 offset:38528
    v_mfma_f32_16x16x32_bf16 v[124:127], a[4:7], a[84:87], v[124:127]
    v_cvt_pk_bf16_f32 v64, v64, v65
    v_cvt_pk_bf16_f32 v65, v66, v67
    v_mfma_f32_16x16x32_bf16 v[128:131], a[8:11], a[80:83], v[128:131]
    s_waitcnt lgkmcnt(8)
    ds_read_b64_tr_b16 a[32:33], v18 offset:37120
    ds_read_b64_tr_b16 a[34:35], v18 offset:38656
    v_mfma_f32_16x16x32_bf16 v[136:139], a[8:11], a[84:87], v[136:139]
    v_cvt_pk_bf16_f32 v66, v68, v69
    v_cvt_pk_bf16_f32 v67, v70, v71
    v_mfma_f32_16x16x32_bf16 v[132:135], a[12:15], a[80:83], v[132:135]
    s_waitcnt lgkmcnt(8)
    ds_read_b64_tr_b16 a[36:37], v19 offset:37120
    ds_read_b64_tr_b16 a[38:39], v19 offset:38656
    v_mfma_f32_16x16x32_bf16 v[140:143], a[12:15], a[84:87], v[140:143]
    v_cvt_pk_bf16_f32 v72, v72, v73
    v_cvt_pk_bf16_f32 v73, v74, v75
    v_cvt_pk_bf16_f32 v74, v76, v77
    v_mfma_f32_16x16x32_bf16 v[144:147], a[16:19], a[80:83], v[144:147]
    s_waitcnt lgkmcnt(8)
    ds_read_b64_tr_b16 a[40:41], v20 offset:37120
    ds_read_b64_tr_b16 a[42:43], v20 offset:38656
    v_mfma_f32_16x16x32_bf16 v[152:155], a[16:19], a[84:87], v[152:155]
    v_cvt_pk_bf16_f32 v75, v78, v79
    v_cvt_pk_bf16_f32 v80, v80, v81
    v_mfma_f32_16x16x32_bf16 v[148:151], a[20:23], a[80:83], v[148:151]
    s_waitcnt lgkmcnt(8)
    ds_read_b64_tr_b16 a[44:45], v21 offset:37120
    ds_read_b64_tr_b16 a[46:47], v21 offset:38656
    v_mfma_f32_16x16x32_bf16 v[156:159], a[20:23], a[84:87], v[156:159]
    v_cvt_pk_bf16_f32 v81, v82, v83
    v_cvt_pk_bf16_f32 v82, v84, v85
    v_cvt_pk_bf16_f32 v83, v86, v87
    v_mfma_f32_16x16x32_bf16 v[112:115], a[24:27], a[88:91], v[112:115]
    s_waitcnt lgkmcnt(8)
    s_waitcnt vmcnt(5)
    ds_read_b64 a[112:113], v160 offset:12288
    ds_read_b64 a[114:115], v161 offset:12288
    v_mfma_f32_16x16x32_bf16 v[120:123], a[24:27], a[92:95], v[120:123]
    ds_read_b64 a[116:117], v160 offset:14336
    ds_read_b64 a[118:119], v161 offset:14336
    v_mfma_f32_16x16x32_bf16 v[116:119], a[28:31], a[88:91], v[116:119]
    s_waitcnt lgkmcnt(10)
    ds_read_b64 a[120:121], v162 offset:12288
    ds_read_b64 a[122:123], v163 offset:12288
    ds_read_b64 a[124:125], v162 offset:14336
    v_mfma_f32_16x16x32_bf16 v[124:127], a[28:31], a[92:95], v[124:127]
    ds_read_b64 a[126:127], v163 offset:14336
    s_waitcnt vmcnt(1)
    ds_read_b64 a[128:129], v160 offset:4096
    v_mfma_f32_16x16x32_bf16 v[128:131], a[32:35], a[88:91], v[128:131]
    s_waitcnt lgkmcnt(13)
    ds_read_b64 a[130:131], v161 offset:4096
    ds_read_b64 a[132:133], v160 offset:6144
    v_mfma_f32_16x16x32_bf16 v[136:139], a[32:35], a[92:95], v[136:139]
    ds_read_b64 a[134:135], v161 offset:6144
    ds_read_b64 a[136:137], v162 offset:4096
    ds_read_b64 a[138:139], v163 offset:4096
    v_mfma_f32_16x16x32_bf16 v[132:135], a[36:39], a[88:91], v[132:135]
    s_waitcnt lgkmcnt(15)
    ds_read_b64 a[140:141], v162 offset:6144
    ds_read_b64 a[142:143], v163 offset:6144
    v_mfma_f32_16x16x32_bf16 v[140:143], a[36:39], a[92:95], v[140:143]
    v_cvt_pk_bf16_f32 v88, v88, v89
    v_cvt_pk_bf16_f32 v89, v90, v91
    v_mfma_f32_16x16x32_bf16 v[144:147], a[40:43], a[88:91], v[144:147]
    s_waitcnt lgkmcnt(15)
    v_cvt_pk_bf16_f32 v90, v92, v93
    v_cvt_pk_bf16_f32 v91, v94, v95
    v_cvt_pk_bf16_f32 v96, v96, v97
    v_mfma_f32_16x16x32_bf16 v[152:155], a[40:43], a[92:95], v[152:155]
    v_cvt_pk_bf16_f32 v97, v98, v99
    v_cvt_pk_bf16_f32 v98, v100, v101
    v_mfma_f32_16x16x32_bf16 v[148:151], a[44:47], a[88:91], v[148:151]
    v_cvt_pk_bf16_f32 v99, v102, v103
    v_cvt_pk_bf16_f32 v104, v104, v105
    v_mfma_f32_16x16x32_bf16 v[156:159], a[44:47], a[92:95], v[156:159]
    v_cvt_pk_bf16_f32 v105, v106, v107
    v_cvt_pk_bf16_f32 v106, v108, v109
    v_cvt_pk_bf16_f32 v107, v110, v111
    s_waitcnt lgkmcnt(15)
    v_mfma_f32_16x16x32_bf16 v[32:35], a[96:99], v[64:67], 0
    v_mfma_f32_16x16x32_bf16 v[36:39], a[100:103], v[64:67], 0
    v_mfma_f32_16x16x32_bf16 v[40:43], a[96:99], v[72:75], 0
    v_cvt_pk_bf16_f32 v112, v112, v113
    v_cvt_pk_bf16_f32 v113, v114, v115
    v_mfma_f32_16x16x32_bf16 v[44:47], a[100:103], v[72:75], 0
    v_cvt_pk_bf16_f32 v114, v116, v117
    v_cvt_pk_bf16_f32 v115, v118, v119
    v_mfma_f32_16x16x32_bf16 v[32:35], a[104:107], v[80:83], v[32:35]
    v_cvt_pk_bf16_f32 v120, v120, v121
    v_cvt_pk_bf16_f32 v121, v122, v123
    v_cvt_pk_bf16_f32 v122, v124, v125
    v_mfma_f32_16x16x32_bf16 v[36:39], a[108:111], v[80:83], v[36:39]
    v_cvt_pk_bf16_f32 v123, v126, v127
    v_cvt_pk_bf16_f32 v128, v128, v129
    v_mfma_f32_16x16x32_bf16 v[40:43], a[104:107], v[88:91], v[40:43]
    v_cvt_pk_bf16_f32 v129, v130, v131
    v_cvt_pk_bf16_f32 v130, v132, v133
    v_cvt_pk_bf16_f32 v131, v134, v135
    v_mfma_f32_16x16x32_bf16 v[44:47], a[108:111], v[88:91], v[44:47]
    v_cvt_pk_bf16_f32 v136, v136, v137
    v_cvt_pk_bf16_f32 v137, v138, v139
    s_waitcnt lgkmcnt(8)
    v_mfma_f32_16x16x32_bf16 v[32:35], a[112:115], v[96:99], v[32:35]
    v_cvt_pk_bf16_f32 v138, v140, v141
    v_cvt_pk_bf16_f32 v139, v142, v143
    v_mfma_f32_16x16x32_bf16 v[36:39], a[116:119], v[96:99], v[36:39]
    v_cvt_pk_bf16_f32 v144, v144, v145
    v_cvt_pk_bf16_f32 v145, v146, v147
    v_cvt_pk_bf16_f32 v146, v148, v149
    v_mfma_f32_16x16x32_bf16 v[40:43], a[112:115], v[104:107], v[40:43]
    v_cvt_pk_bf16_f32 v147, v150, v151
    v_cvt_pk_bf16_f32 v152, v152, v153
    v_mfma_f32_16x16x32_bf16 v[44:47], a[116:119], v[104:107], v[44:47]
    v_cvt_pk_bf16_f32 v153, v154, v155
    v_cvt_pk_bf16_f32 v154, v156, v157
    v_cvt_pk_bf16_f32 v155, v158, v159
    v_mfma_f32_16x16x32_bf16 v[32:35], a[120:123], v[112:115], v[32:35]
    v_mfma_f32_16x16x32_bf16 v[36:39], a[124:127], v[112:115], v[36:39]
    v_mfma_f32_16x16x32_bf16 v[40:43], a[120:123], v[120:123], v[40:43]
    v_mfma_f32_16x16x32_bf16 v[44:47], a[124:127], v[120:123], v[44:47]
    s_waitcnt lgkmcnt(0)
    v_mfma_f32_16x16x32_bf16 v[32:35], a[128:131], v[128:131], v[32:35]
    v_mfma_f32_16x16x32_bf16 v[36:39], a[132:135], v[128:131], v[36:39]
    v_mfma_f32_16x16x32_bf16 v[40:43], a[128:131], v[136:139], v[40:43]
    v_mfma_f32_16x16x32_bf16 v[44:47], a[132:135], v[136:139], v[44:47]
    v_mfma_f32_16x16x32_bf16 v[32:35], a[136:139], v[144:147], v[32:35]
    v_mfma_f32_16x16x32_bf16 v[36:39], a[140:143], v[144:147], v[36:39]
    v_mfma_f32_16x16x32_bf16 v[40:43], a[136:139], v[152:155], v[40:43]
    v_mfma_f32_16x16x32_bf16 v[44:47], a[140:143], v[152:155], v[44:47]
    s_nop 4
    v_max3_f32 v48, v32, v33, v34
    s_nop 0
    v_max3_f32 v50, v40, v41, v42
    v_max3_f32 v48, v48, v35, v36
    v_max3_f32 v50, v50, v43, v44
    v_max3_f32 v48, v48, v37, v38
    v_max3_f32 v50, v50, v45, v46
    v_max_f32 v48, v48, v39
    v_max_f32 v50, v50, v47
    s_mov_b32 s13, 0x3dd53b95
    s_mov_b32 s64, 0x3dd53b95
    v_permlane32_swap_b32 v48, v50
    v_max_f32 v48, v48, v50
    v_mov_b32 v50, v48
    s_nop 1
    v_permlane16_swap_b32 v48, v50
    v_max_f32 v48, v48, v50
    v_mul_f32 v48, s13, v48
    v_mov_b32 v50, v48
    s_nop 1
    v_permlane32_swap_b32 v48, v50
    v_pk_fma_f32 v[32:33], v[32:33], s[64:65], v[48:49] op_sel_hi:[1,0,0] neg_lo:[0,0,1] neg_hi:[0,0,1]
    v_pk_fma_f32 v[34:35], v[34:35], s[64:65], v[48:49] op_sel_hi:[1,0,0] neg_lo:[0,0,1] neg_hi:[0,0,1]
    v_pk_fma_f32 v[36:37], v[36:37], s[64:65], v[48:49] op_sel_hi:[1,0,0] neg_lo:[0,0,1] neg_hi:[0,0,1]
    v_pk_fma_f32 v[38:39], v[38:39], s[64:65], v[48:49] op_sel_hi:[1,0,0] neg_lo:[0,0,1] neg_hi:[0,0,1]
    v_pk_fma_f32 v[40:41], v[40:41], s[64:65], v[50:51] op_sel_hi:[1,0,0] neg_lo:[0,0,1] neg_hi:[0,0,1]
    v_pk_fma_f32 v[42:43], v[42:43], s[64:65], v[50:51] op_sel_hi:[1,0,0] neg_lo:[0,0,1] neg_hi:[0,0,1]
    v_pk_fma_f32 v[44:45], v[44:45], s[64:65], v[50:51] op_sel_hi:[1,0,0] neg_lo:[0,0,1] neg_hi:[0,0,1]
    v_pk_fma_f32 v[46:47], v[46:47], s[64:65], v[50:51] op_sel_hi:[1,0,0] neg_lo:[0,0,1] neg_hi:[0,0,1]
    v_exp_f32 v32, v32
    v_exp_f32 v33, v33
    v_exp_f32 v34, v34
    v_exp_f32 v35, v35
    v_exp_f32 v36, v36
    v_exp_f32 v37, v37
    v_exp_f32 v38, v38
    v_exp_f32 v39, v39
    v_exp_f32 v40, v40
    v_exp_f32 v41, v41
    v_exp_f32 v42, v42
    v_exp_f32 v43, v43
    v_exp_f32 v44, v44
    v_exp_f32 v45, v45
    v_exp_f32 v46, v46
    v_exp_f32 v47, v47
    v_pk_add_f32 v[64:65], v[32:33], v[34:35]
    v_pk_add_f32 v[66:67], v[36:37], v[38:39]
    v_pk_add_f32 v[68:69], v[40:41], v[42:43]
    v_pk_add_f32 v[70:71], v[44:45], v[46:47]
    v_pk_add_f32 v[64:65], v[64:65], v[66:67]
    v_pk_add_f32 v[68:69], v[68:69], v[70:71]
    v_add_f32 v48, v64, v65
    v_add_f32 v50, v68, v69
    s_nop 1
    v_permlane32_swap_b32 v48, v50
    v_add_f32 v48, v48, v50
    v_mov_b32 v50, v48
    s_nop 1
    v_permlane16_swap_b32 v48, v50
    v_add_f32 v48, v48, v50
    v_rcp_f32 v48, v48
    s_nop 0
    v_mov_b32 v50, v48
    s_nop 1
    v_permlane32_swap_b32 v48, v50
    v_pk_mul_f32 v[32:33], v[32:33], v[48:49] op_sel_hi:[1,0]
    v_pk_mul_f32 v[34:35], v[34:35], v[48:49] op_sel_hi:[1,0]
    v_pk_mul_f32 v[36:37], v[36:37], v[48:49] op_sel_hi:[1,0]
    v_pk_mul_f32 v[38:39], v[38:39], v[48:49] op_sel_hi:[1,0]
    v_pk_mul_f32 v[40:41], v[40:41], v[50:51] op_sel_hi:[1,0]
    v_pk_mul_f32 v[42:43], v[42:43], v[50:51] op_sel_hi:[1,0]
    v_pk_mul_f32 v[44:45], v[44:45], v[50:51] op_sel_hi:[1,0]
    v_pk_mul_f32 v[46:47], v[46:47], v[50:51] op_sel_hi:[1,0]
    v_cvt_pk_bf16_f32 v52, v32, v33
    v_cvt_pk_bf16_f32 v53, v34, v35
    v_cvt_pk_bf16_f32 v54, v36, v37
    v_cvt_pk_bf16_f32 v60, v38, v39
    v_cvt_pk_bf16_f32 v56, v40, v41
    v_cvt_pk_bf16_f32 v57, v42, v43
    v_cvt_pk_bf16_f32 v58, v44, v45
    v_cvt_pk_bf16_f32 v61, v46, v47
    buffer_store_dwordx4 v[52:55], v24, s[56:59], s40 offen offset:0
    buffer_store_dwordx4 v[56:59], v24, s[56:59], s40 offen offset:1024
    buffer_store_dwordx4 v[60:63], v24, s[56:59], s40 offen offset:2048
    v_lshrrev_b32 v8, 3, v1
    v_and_b32 v11, 0x70, v24
    v_lshl_or_b32 v11, v8, 10, v11
    s_and_b32 s29, s5, 15
    s_lshl_b32 s29, s29, 5
    s_add_u32 s29, s29, s3
    s_mul_i32 s29, s29, 12288
    s_add_u32 s29, s29, 2104320
    s_lshl_b32 s28, s4, 7
    s_add_u32 s28, s28, s29
    v_add_u32 v16, s8, v24
    v_and_b32 v9, 3, v1
    v_mul_u32_u24 v9, 64, v9
    v_and_b32 v21, 4, v1
    v_lshl_add_u32 v9, v21, 1, v9
    v_add_u32 v9, s8, v9
    v_lshrrev_b32 v10, 4, v1
    v_mul_u32_u24 v10, 7, v10
    v_and_b32 v8, 1, v8
    v_lshl_add_u32 v21, v8, 2, v10
    v_add_u32 v21, 0, v21
    v_and_b32 v22, 2, v21
    v_mul_u32_u24 v22, 124, v22
    v_lshl_add_u32 v22, v21, 2, v22
    v_add_u32 v2, v22, v9
    v_lshl_add_u32 v21, v8, 2, v10
    v_add_u32 v21, 1, v21
    v_and_b32 v22, 2, v21
    v_mul_u32_u24 v22, 124, v22
    v_lshl_add_u32 v22, v21, 2, v22
    v_add_u32 v3, v22, v9
    v_lshl_add_u32 v21, v8, 2, v10
    v_add_u32 v21, 2, v21
    v_and_b32 v22, 2, v21
    v_mul_u32_u24 v22, 124, v22
    v_lshl_add_u32 v22, v21, 2, v22
    v_add_u32 v4, v22, v9
    v_add_u32 v21, 3, v10
    v_and_b32 v22, 2, v21
    v_mul_u32_u24 v22, 124, v22
    v_lshl_add_u32 v22, v21, 2, v22
    v_add_u32 v5, v22, v9
    v_lshl_add_u32 v5, v8, 1, v5
    v_lshrrev_b32 v21, 2, v1
    v_lshrrev_b32 v22, 2, v21
    v_mul_u32_u24 v22, 15360, v22
    v_mul_u32_u24 v21, 1216, v21
    v_add3_u32 v17, v21, v22, v24
    s_lshr_b32 s13, s4, 1
    s_lshl_b32 s27, s7, 2
    s_add_u32 s27, s27, s3
    s_lshl_b32 s27, s27, 3
    s_add_u32 s27, s27, s13
    s_mul_i32 s27, s27, 5120
    s_and_b32 s14, s4, 1
    s_mul_i32 s14, s14, 160
    s_add_u32 s27, s27, s14
    s_mul_i32 s14, s6, 320
    s_add_u32 s27, s27, s14
    s_waitcnt vmcnt(0)
    buffer_store_dwordx4 v[52:55], v24, s[56:59], s51 offen offset:0 sc1
    buffer_store_dwordx4 v[56:59], v24, s[56:59], s51 offen offset:1024 sc1
    buffer_store_dwordx4 v[60:63], v24, s[56:59], s51 offen offset:2048 sc1
    s_add_u32 s20, s28, 0
    s_add_u32 s21, s28, 49152
    s_add_u32 s22, s28, 98304
    s_add_u32 s23, s28, 147456
    s_add_u32 s24, s28, 196608
    s_add_u32 s25, s28, 245760
    s_add_u32 s30, s28, 294912
    s_add_u32 s31, s28, 344064
    s_mov_b32 s17, 20000
    s_mov_b32 exec_hi, 0xff
    v_and_b32 v10, 7, v1
    v_mul_u32_u24 v10, 49152, v10
    v_add_u32 v10, 4220, v10
L_cp0:
    buffer_load_dword v21, v10, s[56:59], s28 offen sc1
    s_waitcnt vmcnt(0)
    v_cmp_ne_u32 vcc, s16, v21
    s_sub_u32 s17, s17, 1
    s_cbranch_scc1 L_cp1
    s_cbranch_vccnz L_cp0
L_cp1:
    s_mov_b32 s17, 20000
L_rs0A:
    buffer_load_dwordx4 v[144:147], v11, s[56:59], s20 offen sc1
    buffer_load_dwordx4 v[148:151], v11, s[56:59], s21 offen sc1
    buffer_load_dwordx4 v[152:155], v11, s[56:59], s22 offen sc1
    buffer_load_dwordx4 v[156:159], v11, s[56:59], s23 offen sc1
    buffer_load_dwordx4 v[160:163], v11, s[56:59], s24 offen sc1
    buffer_load_dwordx4 v[164:167], v11, s[56:59], s25 offen sc1
    buffer_load_dwordx4 v[168:171], v11, s[56:59], s30 offen sc1
    buffer_load_dwordx4 v[172:175], v11, s[56:59], s31 offen sc1
    s_waitcnt vmcnt(7)
    v_lshlrev_b32 v176, 16, v144
    v_and_b32 v177, 0xffff0000, v144
    v_lshlrev_b32 v178, 16, v145
    v_and_b32 v179, 0xffff0000, v145
    v_lshlrev_b32 v180, 16, v146
    v_and_b32 v181, 0xffff0000, v146
    v_lshlrev_b32 v182, 16, v147
    s_waitcnt vmcnt(6)
    v_lshlrev_b32 v192, 16, v148
    v_and_b32 v193, 0xffff0000, v148
    v_lshlrev_b32 v194, 16, v149
    v_and_b32 v195, 0xffff0000, v149
    v_lshlrev_b32 v196, 16, v150
    v_and_b32 v197, 0xffff0000, v150
    v_lshlrev_b32 v198, 16, v151
    v_pk_add_f32 v[176:177], v[176:177], v[192:193]
    v_pk_add_f32 v[178:179], v[178:179], v[194:195]
    v_pk_add_f32 v[180:181], v[180:181], v[196:197]
    v_add_f32 v182, v182, v198
    v_min3_u32 v21, v147, v151, s16
    v_max3_u32 v22, v147, v151, s16
    s_waitcnt vmcnt(5)
    v_lshlrev_b32 v184, 16, v152
    v_and_b32 v185, 0xffff0000, v152
    v_lshlrev_b32 v186, 16, v153
    v_and_b32 v187, 0xffff0000, v153
    v_lshlrev_b32 v188, 16, v154
    v_and_b32 v189, 0xffff0000, v154
    v_lshlrev_b32 v190, 16, v155
    v_pk_add_f32 v[176:177], v[176:177], v[184:185]
    v_pk_add_f32 v[178:179], v[178:179], v[186:187]
    v_pk_add_f32 v[180:181], v[180:181], v[188:189]
    v_add_f32 v182, v182, v190
    s_waitcnt vmcnt(4)
    v_lshlrev_b32 v192, 16, v156
    v_and_b32 v193, 0xffff0000, v156
    v_lshlrev_b32 v194, 16, v157
    v_and_b32 v195, 0xffff0000, v157
    v_lshlrev_b32 v196, 16, v158
    v_and_b32 v197, 0xffff0000, v158
    v_lshlrev_b32 v198, 16, v159
    v_pk_add_f32 v[176:177], v[176:177], v[192:193]
    v_pk_add_f32 v[178:179], v[178:179], v[194:195]
    v_pk_add_f32 v[180:181], v[180:181], v[196:197]
    v_add_f32 v182, v182, v198
    v_min3_u32 v21, v21, v155, v159
    v_max3_u32 v22, v22, v155, v159
    s_waitcnt vmcnt(3)
    v_lshlrev_b32 v184, 16, v160
    v_and_b32 v185, 0xffff0000, v160
    v_lshlrev_b32 v186, 16, v161
    v_and_b32 v187, 0xffff0000, v161
    v_lshlrev_b32 v188, 16, v162
    v_and_b32 v189, 0xffff0000, v162
    v_lshlrev_b32 v190, 16, v163
    v_pk_add_f32 v[176:177], v[176:177], v[184:185]
    v_pk_add_f32 v[178:179], v[178:179], v[186:187]
    v_pk_add_f32 v[180:181], v[180:181], v[188:189]
    v_add_f32 v182, v182, v190
    s_waitcnt vmcnt(2)
    v_lshlrev_b32 v192, 16, v164
    v_and_b32 v193, 0xffff0000, v164
    v_lshlrev_b32 v194, 16, v165
    v_and_b32 v195, 0xffff0000, v165
    v_lshlrev_b32 v196, 16, v166
    v_and_b32 v197, 0xffff0000, v166
    v_lshlrev_b32 v198, 16, v167
    v_pk_add_f32 v[176:177], v[176:177], v[192:193]
    v_pk_add_f32 v[178:179], v[178:179], v[194:195]
    v_pk_add_f32 v[180:181], v[180:181], v[196:197]
    v_add_f32 v182, v182, v198
    v_min3_u32 v21, v21, v163, v167
    v_max3_u32 v22, v22, v163, v167
    s_waitcnt vmcnt(1)
    v_lshlrev_b32 v184, 16, v168
    v_and_b32 v185, 0xffff0000, v168
    v_lshlrev_b32 v186, 16, v169
    v_and_b32 v187, 0xffff0000, v169
    v_lshlrev_b32 v188, 16, v170
    v_and_b32 v189, 0xffff0000, v170
    v_lshlrev_b32 v190, 16, v171
    v_pk_add_f32 v[176:177], v[176:177], v[184:185]
    v_pk_add_f32 v[178:179], v[178:179], v[186:187]
    v_pk_add_f32 v[180:181], v[180:181], v[188:189]
    v_add_f32 v182, v182, v190
    s_waitcnt vmcnt(0)
    v_lshlrev_b32 v192, 16, v172
    v_and_b32 v193, 0xffff0000, v172
    v_lshlrev_b32 v194, 16, v173
    v_and_b32 v195, 0xffff0000, v173
    v_lshlrev_b32 v196, 16, v174
    v_and_b32 v197, 0xffff0000, v174
    v_lshlrev_b32 v198, 16, v175
    v_pk_add_f32 v[176:177], v[176:177], v[192:193]
    v_pk_add_f32 v[178:179], v[178:179], v[194:195]
    v_pk_add_f32 v[180:181], v[180:181], v[196:197]
    v_add_f32 v182, v182, v198
    v_min3_u32 v21, v21, v171, v175
    v_max3_u32 v22, v22, v171, v175
    v_xor_b32 v21, v21, v22
    v_cmp_lt_u32 vcc, 0xffff, v21
    v_cvt_pk_bf16_f32 v200, v176, v177
    v_cvt_pk_bf16_f32 v201, v178, v179
    v_cvt_pk_bf16_f32 v202, v180, v181
    v_cvt_pk_bf16_f32 v203, v182, v182
    s_cbranch_vccz L_rs1A
    s_sub_u32 s17, s17, 1
    s_cbranch_scc0 L_rs0A
L_rs1A:
    ds_write_b32 v2, v200
    ds_write_b32 v3, v201
    s_mov_b32 exec_hi, 0x0
    ds_write_b32 v4, v202
    ds_write_b16 v5, v203
    ds_read_b128 v[204:207], v16
    s_waitcnt lgkmcnt(0)
    buffer_store_dwordx4 v[204:207], v17, s[52:55], s27 offen offset:96 sc1
    s_endpgm
L_st1B:
    s_load_dwordx2 s[56:57], s[0:1], 56
    s_load_dwordx2 s[60:61], s[0:1], 48
    s_load_dwordx2 s[36:37], s[0:1], 8
    s_load_dwordx2 s[52:53], s[0:1], 40
    s_add_u32 s14, s19, 1
    s_mul_i32 s15, s14, 86
    s_lshr_b32 s15, s15, 8
    s_mul_i32 s15, s15, 3
    s_sub_u32 s14, s14, s15
    s_mul_i32 s21, s14, 81920
    s_add_u32 s21, s21, s9
    s_lshl_b32 s27, s14, 7
    s_add_u32 s27, s27, s10
    s_add_u32 s14, s19, 2
    s_mul_i32 s15, s14, 86
    s_lshr_b32 s15, s15, 8
    s_mul_i32 s15, s15, 3
    s_sub_u32 s14, s14, s15
    s_mul_i32 s22, s14, 81920
    s_add_u32 s22, s22, s9
    s_lshl_b32 s28, s14, 7
    s_add_u32 s28, s28, s10
    v_and_b32 v25, 15, v1
    v_lshrrev_b32 v26, 1, v25
    v_lshrrev_b32 v27, 4, v1
    v_xor_b32 v26, v26, v27
    v_lshlrev_b32 v26, 4, v26
    v_lshl_add_u32 v25, v25, 7, v26
    v_add_u32 v16, s8, v25
    v_xor_b32 v17, 64, v16
    v_bfe_u32 v25, v1, 2, 2
    v_lshl_add_u32 v25, v27, 3, v25
    v_mul_u32_u24 v25, 320, v25
    v_and_b32 v26, 2, v1
    v_mul_u32_u24 v26, 80, v26
    v_and_b32 v27, 1, v1
    v_lshl_add_u32 v26, v27, 3, v26
    v_and_b32 v27, 16, v1
    v_add3_u32 v18, v25, v26, v27
    v_xor_b32 v19, 16, v18
    v_add_u32 v20, 49152, v18
    v_add_u32 v21, 49152, v19
    s_cmp_lt_u32 s3, 2
    s_cbranch_scc1 L_st2B
    s_add_u32 m0, s12, 0
    s_nop 0
    buffer_load_dwordx4 v2, s[48:51], s20 offen offset:0  lds
    buffer_load_dwordx4 v3, s[48:51], s20 offen offset:1024  lds
    buffer_load_dwordx4 v4, s[48:51], s20 offen offset:2048  lds
    s_add_u32 m0, s12, 3072
    s_nop 0
    buffer_load_dwordx4 v5, s[48:51], s20 offen offset:0  lds
    buffer_load_dwordx4 v6, s[48:51], s20 offen offset:1024  lds
L_st2B:
    s_add_u32 m0, s8, 12288
    s_add_u32 s66, s26, 12288
    buffer_load_dwordx4 v8, s[40:43], s66 offen offset:0  lds
    buffer_load_dwordx4 v9, s[40:43], s66 offen offset:1024  lds
    buffer_load_dwordx4 v10, s[40:43], s66 offen offset:2048  lds
    buffer_load_dwordx4 v11, s[40:43], s66 offen offset:3072  lds
    v_mov_b32 v0, 0
    s_mov_b32 s58, 268435456
    s_mov_b32 s59, 0x20000
    s_mov_b32 s62, 256
    s_mov_b32 s63, 0x20000
    s_mov_b32 s38, 6291456
    s_mov_b32 s39, 0x20000
    s_mov_b32 s54, 655360
    s_mov_b32 s55, 0x20000
    s_and_b32 s11, s5, 15
    s_lshl_b32 s11, s11, 3
    s_add_u32 s11, s11, s4
    s_lshl_b32 s11, s11, 2
    s_add_u32 s11, s11, s3
    s_mul_i32 s11, s11, 12288
    s_add_u32 s11, s11, 2097152
    s_lshl_b32 s13, s7, 2
    s_add_u32 s13, s13, s3
    s_lshl_b32 s13, s13, 5
    s_lshl_b32 s14, s4, 2
    s_add_u32 s13, s13, s14
    s_mul_i32 s13, s13, 3072
    s_waitcnt lgkmcnt(0)
    s_lshl_b32 s13, s7, 2
    s_add_u32 s13, s13, s3
    s_lshl_b32 s13, s13, 5
    s_lshl_b32 s14, s4, 2
    s_add_u32 s13, s13, s14
    s_mul_i32 s13, s13, 3072
    s_add_u32 s32, s13, 0
    s_add_u32 s33, s13, 3072
    s_add_u32 s34, s13, 6144
    s_add_u32 s35, s13, 9216
    s_add_u32 s44, s11, 0
    s_add_u32 s45, s11, 4096
    s_add_u32 s46, s11, 8192
    s_mov_b32 s47, s13
    v_and_b32 v12, 12, v1
    v_lshlrev_b32 v12, 6, v12
    v_and_b32 v13, 48, v1
    v_lshl_or_b32 v12, v13, 2, v12
    v_and_b32 v13, 3, v1
    v_lshl_or_b32 v12, v13, 4, v12
    v_and_b32 v13, 3, v1
    v_mul_u32_u24 v13, 3072, v13
    s_cmp_ge_u32 s3, 2
    s_cbranch_scc1 L_st3B
    s_waitcnt vmcnt(4)
L_st3B:
    s_waitcnt vmcnt(9)
    s_barrier
    ds_read_b128 a[64:67], v16 offset:0
    ds_read_b128 a[68:71], v16 offset:2048
    ds_read_b128 a[72:75], v17 offset:0
    ds_read_b128 a[76:79], v17 offset:2048
    ds_read_b64_tr_b16 a[0:1], v18 offset:0
    ds_read_b64_tr_b16 a[2:3], v18 offset:1280
    ds_read_b64_tr_b16 a[4:5], v19 offset:0
    ds_read_b64_tr_b16 a[6:7], v19 offset:1280
    ds_read_b64_tr_b16 a[8:9], v18 offset:32
    ds_read_b64_tr_b16 a[10:11], v18 offset:1312
    ds_read_b64_tr_b16 a[12:13], v19 offset:32
    ds_read_b64_tr_b16 a[14:15], v19 offset:1312
    ds_read_b64_tr_b16 a[16:17], v18 offset:64
    ds_read_b64_tr_b16 a[18:19], v18 offset:1344
    s_waitcnt lgkmcnt(8)
    v_mfma_f32_16x16x32_bf16 v[32:35], a[64:67], a[0:3], 0
    s_waitcnt lgkmcnt(6)
    ds_read_b64_tr_b16 a[20:21], v19 offset:64
    ds_read_b64_tr_b16 a[22:23], v19 offset:1344
    v_mfma_f32_16x16x32_bf16 v[36:39], a[68:71], a[0:3], 0
    s_add_u32 m0, s8, 4096
    s_nop 0
    buffer_load_dwordx4 v8, s[40:43], s27 offen offset:0  lds
    v_mfma_f32_16x16x32_bf16 v[40:43], a[64:67], a[4:7], 0
    s_waitcnt lgkmcnt(6)
    ds_read_b64_tr_b16 a[24:25], v18 offset:96
    ds_read_b64_tr_b16 a[26:27], v18 offset:1376
    v_mfma_f32_16x16x32_bf16 v[44:47], a[68:71], a[4:7], 0
    buffer_load_dwordx4 v9, s[40:43], s27 offen offset:1024  lds
    buffer_load_dwordx4 v10, s[40:43], s27 offen offset:2048  lds
    v_mfma_f32_16x16x32_bf16 v[48:51], a[64:67], a[8:11], 0
    s_waitcnt lgkmcnt(6)
    ds_read_b64_tr_b16 a[28:29], v19 offset:96
    ds_read_b64_tr_b16 a[30:31], v19 offset:1376
    v_mfma_f32_16x16x32_bf16 v[52:55], a[68:71], a[8:11], 0
    buffer_load_dwordx4 v11, s[40:43], s27 offen offset:3072  lds
    s_add_u32 m0, s12, 24576
    s_nop 0
    buffer_load_dwordx4 v2, s[48:51], s21 offen offset:0  lds
    v_mfma_f32_16x16x32_bf16 v[56:59], a[64:67], a[12:15], 0
    s_waitcnt lgkmcnt(6)
    ds_read_b64_tr_b16 a[32:33], v18 offset:128
    ds_read_b64_tr_b16 a[34:35], v18 offset:1408
    v_mfma_f32_16x16x32_bf16 v[60:63], a[68:71], a[12:15], 0
    buffer_load_dwordx4 v3, s[48:51], s21 offen offset:1024  lds
    buffer_load_dwordx4 v4, s[48:51], s21 offen offset:2048  lds
    v_mfma_f32_16x16x32_bf16 v[64:67], a[64:67], a[16:19], 0
    s_waitcnt lgkmcnt(6)
    ds_read_b64_tr_b16 a[36:37], v19 offset:128
    ds_read_b64_tr_b16 a[38:39], v19 offset:1408
    v_mfma_f32_16x16x32_bf16 v[68:71], a[68:71], a[16:19], 0
    s_add_u32 m0, s12, 27648
    s_nop 0
    buffer_load_dwordx4 v5, s[48:51], s21 offen offset:0  lds
    buffer_load_dwordx4 v6, s[48:51], s21 offen offset:1024  lds
    v_mfma_f32_16x16x32_bf16 v[72:75], a[64:67], a[20:23], 0
    s_waitcnt vmcnt(13)
    s_barrier
    s_waitcnt lgkmcnt(6)
    ds_read_b64_tr_b16 a[0:1], v18 offset:10240
    ds_read_b64_tr_b16 a[2:3], v18 offset:11520
    v_mfma_f32_16x16x32_bf16 v[76:79], a[68:71], a[20:23], 0
    v_mfma_f32_16x16x32_bf16 v[80:83], a[64:67], a[24:27], 0
    s_waitcnt lgkmcnt(6)
    ds_read_b64_tr_b16 a[4:5], v19 offset:10240
    ds_read_b64_tr_b16 a[6:7], v19 offset:11520
    v_mfma_f32_16x16x32_bf16 v[84:87], a[68:71], a[24:27], 0
    s_add_u32 m0, s12, 73728
    s_add_u32 s67, s20, 245760
    buffer_load_dwordx4 v2, s[48:51], s67 offen offset:0  lds
    v_mfma_f32_16x16x32_bf16 v[88:91], a[64:67], a[28:31], 0
    s_waitcnt lgkmcnt(6)
    ds_read_b64_tr_b16 a[8:9], v18 offset:10272
    ds_read_b64_tr_b16 a[10:11], v18 offset:11552
    v_mfma_f32_16x16x32_bf16 v[92:95], a[68:71], a[28:31], 0
    v_mfma_f32_16x16x32_bf16 v[96:99], a[64:67], a[32:35], 0
    s_waitcnt lgkmcnt(6)
    ds_read_b64_tr_b16 a[12:13], v19 offset:10272
    ds_read_b64_tr_b16 a[14:15], v19 offset:11552
    v_mfma_f32_16x16x32_bf16 v[100:103], a[68:71], a[32:35], 0
    buffer_load_dwordx4 v3, s[48:51], s67 offen offset:1024  lds
    v_mfma_f32_16x16x32_bf16 v[104:107], a[64:67], a[36:39], 0
    s_waitcnt lgkmcnt(6)
    ds_read_b64_tr_b16 a[16:17], v18 offset:10304
    ds_read_b64_tr_b16 a[18:19], v18 offset:11584
    v_mfma_f32_16x16x32_bf16 v[108:111], a[68:71], a[36:39], 0
    buffer_load_dwordx4 v4, s[48:51], s67 offen offset:2048  lds
    v_mfma_f32_16x16x32_bf16 v[32:35], a[72:75], a[0:3], v[32:35]
    s_waitcnt lgkmcnt(6)
    ds_read_b64_tr_b16 a[20:21], v19 offset:10304
    ds_read_b64_tr_b16 a[22:23], v19 offset:11584
    v_mfma_f32_16x16x32_bf16 v[36:39], a[76:79], a[0:3], v[36:39]
    v_mfma_f32_16x16x32_bf16 v[40:43], a[72:75], a[4:7], v[40:43]
    s_waitcnt lgkmcnt(6)
    ds_read_b64_tr_b16 a[24:25], v18 offset:10336
    ds_read_b64_tr_b16 a[26:27], v18 offset:11616
    v_mfma_f32_16x16x32_bf16 v[44:47], a[76:79], a[4:7], v[44:47]
    v_mfma_f32_16x16x32_bf16 v[48:51], a[72:75], a[8:11], v[48:51]
    s_waitcnt lgkmcnt(6)
    ds_read_b64_tr_b16 a[28:29], v19 offset:10336
    ds_read_b64_tr_b16 a[30:31], v19 offset:11616
    v_mfma_f32_16x16x32_bf16 v[52:55], a[76:79], a[8:11], v[52:55]
    s_add_u32 m0, s12, 76800
    s_nop 0
    buffer_load_dwordx4 v5, s[48:51], s67 offen offset:0  lds
    v_mfma_f32_16x16x32_bf16 v[56:59], a[72:75], a[12:15], v[56:59]
    s_waitcnt lgkmcnt(6)
    ds_read_b64_tr_b16 a[32:33], v18 offset:10368
    ds_read_b64_tr_b16 a[34:35], v18 offset:11648
    v_mfma_f32_16x16x32_bf16 v[60:63], a[76:79], a[12:15], v[60:63]
    v_mfma_f32_16x16x32_bf16 v[64:67], a[72:75], a[16:19], v[64:67]
    s_waitcnt lgkmcnt(6)
    ds_read_b64_tr_b16 a[36:37], v19 offset:10368
    ds_read_b64_tr_b16 a[38:39], v19 offset:11648
    v_mfma_f32_16x16x32_bf16 v[68:71], a[76:79], a[16:19], v[68:71]
    buffer_load_dwordx4 v6, s[48:51], s67 offen offset:1024  lds
    v_mfma_f32_16x16x32_bf16 v[72:75], a[72:75], a[20:23], v[72:75]
    s_waitcnt vmcnt(5)
    s_barrier
    s_waitcnt lgkmcnt(6)
    ds_read_b128 a[80:83], v16 offset:4096
    ds_read_b128 a[84:87], v16 offset:6144
    v_mfma_f32_16x16x32_bf16 v[76:79], a[76:79], a[20:23], v[76:79]
    ds_read_b128 a[88:91], v17 offset:4096
    v_mfma_f32_16x16x32_bf16 v[80:83], a[72:75], a[24:27], v[80:83]
    s_waitcnt lgkmcnt(7)
    ds_read_b128 a[92:95], v17 offset:6144
    ds_read_b64_tr_b16 a[0:1], v18 offset:24576
    v_mfma_f32_16x16x32_bf16 v[84:87], a[76:79], a[24:27], v[84:87]
    ds_read_b64_tr_b16 a[2:3], v18 offset:25856
    s_add_u32 m0, s8, 8192
    s_nop 0
    buffer_load_dwordx4 v8, s[40:43], s28 offen offset:0  lds
    v_mfma_f32_16x16x32_bf16 v[88:91], a[72:75], a[28:31], v[88:91]
    s_waitcnt lgkmcnt(8)
    ds_read_b64_tr_b16 a[4:5], v19 offset:24576
    ds_read_b64_tr_b16 a[6:7], v19 offset:25856
    v_mfma_f32_16x16x32_bf16 v[92:95], a[76:79], a[28:31], v[92:95]
    ds_read_b64_tr_b16 a[8:9], v18 offset:24608
    v_mfma_f32_16x16x32_bf16 v[96:99], a[72:75], a[32:35], v[96:99]
    s_waitcnt lgkmcnt(9)
    ds_read_b64_tr_b16 a[10:11], v18 offset:25888
    ds_read_b64_tr_b16 a[12:13], v19 offset:24608
    v_mfma_f32_16x16x32_bf16 v[100:103], a[76:79], a[32:35], v[100:103]
    ds_read_b64_tr_b16 a[14:15], v19 offset:25888
    buffer_load_dwordx4 v9, s[40:43], s28 offen offset:1024  lds
    v_mfma_f32_16x16x32_bf16 v[104:107], a[72:75], a[36:39], v[104:107]
    s_waitcnt lgkmcnt(6)
    ds_read_b64_tr_b16 a[16:17], v18 offset:24640
    ds_read_b64_tr_b16 a[18:19], v18 offset:25920
    v_mfma_f32_16x16x32_bf16 v[108:111], a[76:79], a[36:39], v[108:111]
    buffer_load_dwordx4 v10, s[40:43], s28 offen offset:2048  lds
    v_mfma_f32_16x16x32_bf16 v[32:35], a[80:83], a[0:3], v[32:35]
    s_waitcnt lgkmcnt(6)
    ds_read_b64_tr_b16 a[20:21], v19 offset:24640
    ds_read_b64_tr_b16 a[22:23], v19 offset:25920
    v_mfma_f32_16x16x32_bf16 v[36:39], a[84:87], a[0:3], v[36:39]
    v_mfma_f32_16x16x32_bf16 v[40:43], a[80:83], a[4:7], v[40:43]
    s_waitcnt lgkmcnt(6)
    ds_read_b64_tr_b16 a[24:25], v18 offset:24672
    ds_read_b64_tr_b16 a[26:27], v18 offset:25952
    v_mfma_f32_16x16x32_bf16 v[44:47], a[84:87], a[4:7], v[44:47]
    v_mfma_f32_16x16x32_bf16 v[48:51], a[80:83], a[8:11], v[48:51]
    s_waitcnt lgkmcnt(6)
    ds_read_b64_tr_b16 a[28:29], v19 offset:24672
    ds_read_b64_tr_b16 a[30:31], v19 offset:25952
    v_mfma_f32_16x16x32_bf16 v[52:55], a[84:87], a[8:11], v[52:55]
    buffer_load_dwordx4 v11, s[40:43], s28 offen offset:3072  lds
    v_mfma_f32_16x16x32_bf16 v[56:59], a[80:83], a[12:15], v[56:59]
    s_waitcnt lgkmcnt(6)
    ds_read_b64_tr_b16 a[32:33], v18 offset:24704
    ds_read_b64_tr_b16 a[34:35], v18 offset:25984
    v_mfma_f32_16x16x32_bf16 v[60:63], a[84:87], a[12:15], v[60:63]
    v_mfma_f32_16x16x32_bf16 v[64:67], a[80:83], a[16:19], v[64:67]
    s_waitcnt lgkmcnt(6)
    ds_read_b64_tr_b16 a[36:37], v19 offset:24704
    ds_read_b64_tr_b16 a[38:39], v19 offset:25984
    v_mfma_f32_16x16x32_bf16 v[68:71], a[84:87], a[16:19], v[68:71]
    s_add_u32 m0, s12, 49152
    s_nop 0
    buffer_load_dwordx4 v2, s[48:51], s22 offen offset:0  lds
    v_mfma_f32_16x16x32_bf16 v[72:75], a[80:83], a[20:23], v[72:75]
    s_waitcnt lgkmcnt(6)
    ds_read_b64_tr_b16 a[0:1], v18 offset:34816
    ds_read_b64_tr_b16 a[2:3], v18 offset:36096
    v_mfma_f32_16x16x32_bf16 v[76:79], a[84:87], a[20:23], v[76:79]
    v_mfma_f32_16x16x32_bf16 v[80:83], a[80:83], a[24:27], v[80:83]
    s_waitcnt lgkmcnt(6)
    ds_read_b64_tr_b16 a[4:5], v19 offset:34816
    ds_read_b64_tr_b16 a[6:7], v19 offset:36096
    v_mfma_f32_16x16x32_bf16 v[84:87], a[84:87], a[24:27], v[84:87]
    v_mfma_f32_16x16x32_bf16 v[88:91], a[80:83], a[28:31], v[88:91]
    s_waitcnt lgkmcnt(6)
    ds_read_b64_tr_b16 a[8:9], v18 offset:34848
    ds_read_b64_tr_b16 a[10:11], v18 offset:36128
    v_mfma_f32_16x16x32_bf16 v[92:95], a[84:87], a[28:31], v[92:95]
    buffer_load_dwordx4 v3, s[48:51], s22 offen offset:1024  lds
    v_mfma_f32_16x16x32_bf16 v[96:99], a[80:83], a[32:35], v[96:99]
    s_waitcnt lgkmcnt(6)
    ds_read_b64_tr_b16 a[12:13], v19 offset:34848
    ds_read_b64_tr_b16 a[14:15], v19 offset:36128
    v_mfma_f32_16x16x32_bf16 v[100:103], a[84:87], a[32:35], v[100:103]
    v_mfma_f32_16x16x32_bf16 v[104:107], a[80:83], a[36:39], v[104:107]
    s_waitcnt lgkmcnt(6)
    ds_read_b64_tr_b16 a[16:17], v18 offset:34880
    ds_read_b64_tr_b16 a[18:19], v18 offset:36160
    v_mfma_f32_16x16x32_bf16 v[108:111], a[84:87], a[36:39], v[108:111]
    buffer_load_dwordx4 v4, s[48:51], s22 offen offset:2048  lds
    v_mfma_f32_16x16x32_bf16 v[32:35], a[88:91], a[0:3], v[32:35]
    s_waitcnt lgkmcnt(6)
    ds_read_b64_tr_b16 a[20:21], v19 offset:34880
    ds_read_b64_tr_b16 a[22:23], v19 offset:36160
    v_mfma_f32_16x16x32_bf16 v[36:39], a[92:95], a[0:3], v[36:39]
    v_mfma_f32_16x16x32_bf16 v[40:43], a[88:91], a[4:7], v[40:43]
    s_waitcnt lgkmcnt(6)
    ds_read_b64_tr_b16 a[24:25], v18 offset:34912
    ds_read_b64_tr_b16 a[26:27], v18 offset:36192
    v_mfma_f32_16x16x32_bf16 v[44:47], a[92:95], a[4:7], v[44:47]
    v_mfma_f32_16x16x32_bf16 v[48:51], a[88:91], a[8:11], v[48:51]
    s_waitcnt lgkmcnt(6)
    ds_read_b64_tr_b16 a[28:29], v19 offset:34912
    ds_read_b64_tr_b16 a[30:31], v19 offset:36192
    v_mfma_f32_16x16x32_bf16 v[52:55], a[92:95], a[8:11], v[52:55]
    s_add_u32 m0, s12, 52224
    s_nop 0
    buffer_load_dwordx4 v5, s[48:51], s22 offen offset:0  lds
    v_mfma_f32_16x16x32_bf16 v[56:59], a[88:91], a[12:15], v[56:59]
    s_waitcnt lgkmcnt(6)
    ds_read_b64_tr_b16 a[32:33], v18 offset:34944
    ds_read_b64_tr_b16 a[34:35], v18 offset:36224
    v_mfma_f32_16x16x32_bf16 v[60:63], a[92:95], a[12:15], v[60:63]
    v_mfma_f32_16x16x32_bf16 v[64:67], a[88:91], a[16:19], v[64:67]
    s_waitcnt lgkmcnt(6)
    ds_read_b64_tr_b16 a[36:37], v19 offset:34944
    ds_read_b64_tr_b16 a[38:39], v19 offset:36224
    v_mfma_f32_16x16x32_bf16 v[68:71], a[92:95], a[16:19], v[68:71]
    buffer_load_dwordx4 v6, s[48:51], s22 offen offset:1024  lds
    v_mfma_f32_16x16x32_bf16 v[72:75], a[88:91], a[20:23], v[72:75]
    s_waitcnt vmcnt(0)
    s_barrier
    s_waitcnt lgkmcnt(6)
    ds_read_b128 a[64:67], v16 offset:8192
    ds_read_b128 a[68:71], v16 offset:10240
    v_mfma_f32_16x16x32_bf16 v[76:79], a[92:95], a[20:23], v[76:79]
    ds_read_b128 a[72:75], v17 offset:8192
    v_mfma_f32_16x16x32_bf16 v[80:83], a[88:91], a[24:27], v[80:83]
    s_waitcnt lgkmcnt(7)
    ds_read_b128 a[76:79], v17 offset:10240
    ds_read_b64_tr_b16 a[0:1], v20 offset:0
    v_mfma_f32_16x16x32_bf16 v[84:87], a[92:95], a[24:27], v[84:87]
    ds_read_b64_tr_b16 a[2:3], v20 offset:1280
    s_add_u32 m0, s8, 0
    s_add_u32 s64, s27, 12288
    buffer_load_dwordx4 v8, s[40:43], s64 offen offset:0  lds
    v_mfma_f32_16x16x32_bf16 v[88:91], a[88:91], a[28:31], v[88:91]
    s_waitcnt lgkmcnt(8)
    ds_read_b64_tr_b16 a[4:5], v21 offset:0
    ds_read_b64_tr_b16 a[6:7], v21 offset:1280
    v_mfma_f32_16x16x32_bf16 v[92:95], a[92:95], a[28:31], v[92:95]
    ds_read_b64_tr_b16 a[8:9], v20 offset:32
    v_mfma_f32_16x16x32_bf16 v[96:99], a[88:91], a[32:35], v[96:99]
    s_waitcnt lgkmcnt(9)
    ds_read_b64_tr_b16 a[10:11], v20 offset:1312
    ds_read_b64_tr_b16 a[12:13], v21 offset:32
    v_mfma_f32_16x16x32_bf16 v[100:103], a[92:95], a[32:35], v[100:103]
    ds_read_b64_tr_b16 a[14:15], v21 offset:1312
    buffer_load_dwordx4 v9, s[40:43], s64 offen offset:1024  lds
    v_mfma_f32_16x16x32_bf16 v[104:107], a[88:91], a[36:39], v[104:107]
    s_waitcnt lgkmcnt(6)
    ds_read_b64_tr_b16 a[16:17], v20 offset:64
    ds_read_b64_tr_b16 a[18:19], v20 offset:1344
    v_mfma_f32_16x16x32_bf16 v[108:111], a[92:95], a[36:39], v[108:111]
    buffer_load_dwordx4 v10, s[40:43], s64 offen offset:2048  lds
    v_mfma_f32_16x16x32_bf16 v[32:35], a[64:67], a[0:3], v[32:35]
    s_waitcnt lgkmcnt(6)
    ds_read_b64_tr_b16 a[20:21], v20 offset:10240
    ds_read_b64_tr_b16 a[22:23], v20 offset:11520
    v_mfma_f32_16x16x32_bf16 v[36:39], a[68:71], a[0:3], v[36:39]
    v_mfma_f32_16x16x32_bf16 v[40:43], a[64:67], a[4:7], v[40:43]
    s_waitcnt lgkmcnt(6)
    ds_read_b64_tr_b16 a[24:25], v21 offset:10240
    ds_read_b64_tr_b16 a[26:27], v21 offset:11520
    v_mfma_f32_16x16x32_bf16 v[44:47], a[68:71], a[4:7], v[44:47]
    v_mfma_f32_16x16x32_bf16 v[48:51], a[64:67], a[8:11], v[48:51]
    s_waitcnt lgkmcnt(6)
    ds_read_b64_tr_b16 a[28:29], v20 offset:10272
    ds_read_b64_tr_b16 a[30:31], v20 offset:11552
    v_mfma_f32_16x16x32_bf16 v[52:55], a[68:71], a[8:11], v[52:55]
    buffer_load_dwordx4 v11, s[40:43], s64 offen offset:3072  lds
    v_mfma_f32_16x16x32_bf16 v[56:59], a[64:67], a[12:15], v[56:59]
    s_waitcnt lgkmcnt(6)
    ds_read_b64_tr_b16 a[32:33], v21 offset:10272
    ds_read_b64_tr_b16 a[34:35], v21 offset:11552
    v_mfma_f32_16x16x32_bf16 v[60:63], a[68:71], a[12:15], v[60:63]
    v_mfma_f32_16x16x32_bf16 v[64:67], a[64:67], a[16:19], v[64:67]
    s_waitcnt lgkmcnt(6)
    ds_read_b64_tr_b16 a[36:37], v20 offset:10304
    ds_read_b64_tr_b16 a[38:39], v20 offset:11584
    v_mfma_f32_16x16x32_bf16 v[68:71], a[68:71], a[16:19], v[68:71]
    s_add_u32 m0, s12, 0
    s_add_u32 s65, s21, 245760
    buffer_load_dwordx4 v2, s[48:51], s65 offen offset:0  lds
    v_mfma_f32_16x16x32_bf16 v[32:35], a[72:75], a[20:23], v[32:35]
    s_waitcnt lgkmcnt(6)
    ds_read_b64_tr_b16 a[0:1], v21 offset:64
    ds_read_b64_tr_b16 a[2:3], v21 offset:1344
    v_mfma_f32_16x16x32_bf16 v[36:39], a[76:79], a[20:23], v[36:39]
    v_mfma_f32_16x16x32_bf16 v[40:43], a[72:75], a[24:27], v[40:43]
    s_waitcnt lgkmcnt(6)
    ds_read_b64_tr_b16 a[4:5], v20 offset:96
    ds_read_b64_tr_b16 a[6:7], v20 offset:1376
    v_mfma_f32_16x16x32_bf16 v[44:47], a[76:79], a[24:27], v[44:47]
    v_mfma_f32_16x16x32_bf16 v[48:51], a[72:75], a[28:31], v[48:51]
    s_waitcnt lgkmcnt(6)
    ds_read_b64_tr_b16 a[8:9], v21 offset:96
    ds_read_b64_tr_b16 a[10:11], v21 offset:1376
    v_mfma_f32_16x16x32_bf16 v[52:55], a[76:79], a[28:31], v[52:55]
    buffer_load_dwordx4 v3, s[48:51], s65 offen offset:1024  lds
    v_mfma_f32_16x16x32_bf16 v[56:59], a[72:75], a[32:35], v[56:59]
    s_waitcnt lgkmcnt(6)
    ds_read_b64_tr_b16 a[12:13], v20 offset:128
    ds_read_b64_tr_b16 a[14:15], v20 offset:1408
    v_mfma_f32_16x16x32_bf16 v[60:63], a[76:79], a[32:35], v[60:63]
    v_mfma_f32_16x16x32_bf16 v[64:67], a[72:75], a[36:39], v[64:67]
    s_waitcnt lgkmcnt(6)
    ds_read_b64_tr_b16 a[16:17], v21 offset:128
    ds_read_b64_tr_b16 a[18:19], v21 offset:1408
    v_mfma_f32_16x16x32_bf16 v[68:71], a[76:79], a[36:39], v[68:71]
    buffer_load_dwordx4 v4, s[48:51], s65 offen offset:2048  lds
    v_mfma_f32_16x16x32_bf16 v[72:75], a[64:67], a[0:3], v[72:75]
    s_waitcnt lgkmcnt(6)
    ds_read_b64_tr_b16 a[20:21], v21 offset:10304
    ds_read_b64_tr_b16 a[22:23], v21 offset:11584
    v_mfma_f32_16x16x32_bf16 v[76:79], a[68:71], a[0:3], v[76:79]
    v_mfma_f32_16x16x32_bf16 v[80:83], a[64:67], a[4:7], v[80:83]
    s_waitcnt lgkmcnt(6)
    ds_read_b64_tr_b16 a[24:25], v20 offset:10336
    ds_read_b64_tr_b16 a[26:27], v20 offset:11616
    v_mfma_f32_16x16x32_bf16 v[84:87], a[68:71], a[4:7], v[84:87]
    v_mfma_f32_16x16x32_bf16 v[88:91], a[64:67], a[8:11], v[88:91]
    s_waitcnt lgkmcnt(6)
    ds_read_b64_tr_b16 a[28:29], v21 offset:10336
    ds_read_b64_tr_b16 a[30:31], v21 offset:11616
    v_mfma_f32_16x16x32_bf16 v[92:95], a[68:71], a[8:11], v[92:95]
    v_cvt_pk_bf16_f32 v112, v32, v33
    v_cvt_pk_bf16_f32 v113, v34, v35
    s_add_u32 m0, s12, 3072
    s_nop 0
    buffer_load_dwordx4 v5, s[48:51], s65 offen offset:0  lds
    v_cvt_pk_bf16_f32 v114, v36, v37
    v_cvt_pk_bf16_f32 v115, v38, v39
    v_mfma_f32_16x16x32_bf16 v[96:99], a[64:67], a[12:15], v[96:99]
    s_waitcnt lgkmcnt(6)
    ds_read_b64_tr_b16 a[32:33], v20 offset:10368
    ds_read_b64_tr_b16 a[34:35], v20 offset:11648
    v_mfma_f32_16x16x32_bf16 v[100:103], a[68:71], a[12:15], v[100:103]
    v_cvt_pk_bf16_f32 v116, v40, v41
    v_cvt_pk_bf16_f32 v117, v42, v43
    v_mfma_f32_16x16x32_bf16 v[104:107], a[64:67], a[16:19], v[104:107]
    s_waitcnt lgkmcnt(6)
    ds_read_b64_tr_b16 a[36:37], v21 offset:10368
    ds_read_b64_tr_b16 a[38:39], v21 offset:11648
    v_mfma_f32_16x16x32_bf16 v[108:111], a[68:71], a[16:19], v[108:111]
    v_cvt_pk_bf16_f32 v118, v44, v45
    v_cvt_pk_bf16_f32 v119, v46, v47
    buffer_load_dwordx4 v6, s[48:51], s65 offen offset:1024  lds
    v_cvt_pk_bf16_f32 v120, v48, v49
    v_cvt_pk_bf16_f32 v121, v50, v51
    v_mfma_f32_16x16x32_bf16 v[72:75], a[72:75], a[20:23], v[72:75]
    s_waitcnt vmcnt(18)
    s_barrier
    s_waitcnt lgkmcnt(6)
    ds_read_b128 a[80:83], v16 offset:12288
    ds_read_b128 a[84:87], v16 offset:14336
    v_mfma_f32_16x16x32_bf16 v[76:79], a[76:79], a[20:23], v[76:79]
    ds_read_b128 a[88:91], v17 offset:12288
    v_mfma_f32_16x16x32_bf16 v[80:83], a[72:75], a[24:27], v[80:83]
    s_waitcnt lgkmcnt(7)
    ds_read_b128 a[92:95], v17 offset:14336
    ds_read_b64_tr_b16 a[0:1], v20 offset:24576
    v_mfma_f32_16x16x32_bf16 v[84:87], a[76:79], a[24:27], v[84:87]
    ds_read_b64_tr_b16 a[2:3], v20 offset:25856
    s_add_u32 m0, s8, 4096
    s_add_u32 s66, s28, 12288
    buffer_load_dwordx4 v8, s[40:43], s66 offen offset:0  lds
    v_cvt_pk_bf16_f32 v122, v52, v53
    v_cvt_pk_bf16_f32 v123, v54, v55
    v_mfma_f32_16x16x32_bf16 v[88:91], a[72:75], a[28:31], v[88:91]
    s_waitcnt lgkmcnt(8)
    ds_read_b64_tr_b16 a[4:5], v21 offset:24576
    ds_read_b64_tr_b16 a[6:7], v21 offset:25856
    v_mfma_f32_16x16x32_bf16 v[92:95], a[76:79], a[28:31], v[92:95]
    ds_read_b64_tr_b16 a[8:9], v20 offset:24608
    buffer_load_dwordx4 v9, s[40:43], s66 offen offset:1024  lds
    v_cvt_pk_bf16_f32 v124, v56, v57
    v_cvt_pk_bf16_f32 v125, v58, v59
    v_mfma_f32_16x16x32_bf16 v[96:99], a[72:75], a[32:35], v[96:99]
    s_waitcnt lgkmcnt(9)
    ds_read_b64_tr_b16 a[10:11], v20 offset:25888
    ds_read_b64_tr_b16 a[12:13], v21 offset:24608
    v_mfma_f32_16x16x32_bf16 v[100:103], a[76:79], a[32:35], v[100:103]
    ds_read_b64_tr_b16 a[14:15], v21 offset:25888
    v_cvt_pk_bf16_f32 v126, v60, v61
    v_cvt_pk_bf16_f32 v127, v62, v63
    buffer_load_dwordx4 v10, s[40:43], s66 offen offset:2048  lds
    v_mfma_f32_16x16x32_bf16 v[104:107], a[72:75], a[36:39], v[104:107]
    s_waitcnt lgkmcnt(6)
    ds_read_b64_tr_b16 a[16:17], v20 offset:24640
    ds_read_b64_tr_b16 a[18:19], v20 offset:25920
    v_mfma_f32_16x16x32_bf16 v[108:111], a[76:79], a[36:39], v[108:111]
    v_cvt_pk_bf16_f32 v128, v64, v65
    v_cvt_pk_bf16_f32 v129, v66, v67
    buffer_load_dwordx4 v11, s[40:43], s66 offen offset:3072  lds
    v_cvt_pk_bf16_f32 v130, v68, v69
    v_cvt_pk_bf16_f32 v131, v70, v71
    v_mfma_f32_16x16x32_bf16 v[32:35], a[80:83], a[0:3], 0
    s_waitcnt lgkmcnt(6)
    ds_read_b64_tr_b16 a[20:21], v20 offset:34816
    ds_read_b64_tr_b16 a[22:23], v20 offset:36096
    v_mfma_f32_16x16x32_bf16 v[36:39], a[84:87], a[0:3], 0
    v_mfma_f32_16x16x32_bf16 v[40:43], a[80:83], a[4:7], 0
    s_waitcnt lgkmcnt(6)
    ds_read_b64_tr_b16 a[24:25], v21 offset:34816
    ds_read_b64_tr_b16 a[26:27], v21 offset:36096
    v_mfma_f32_16x16x32_bf16 v[44:47], a[84:87], a[4:7], 0
    s_add_u32 m0, s12, 24576
    s_add_u32 s67, s22, 245760
    buffer_load_dwordx4 v2, s[48:51], s67 offen offset:0  lds
    v_cvt_pk_bf16_f32 v132, v72, v73
    v_cvt_pk_bf16_f32 v133, v74, v75
    v_mfma_f32_16x16x32_bf16 v[48:51], a[80:83], a[8:11], 0
    s_waitcnt lgkmcnt(6)
    ds_read_b64_tr_b16 a[28:29], v20 offset:34848
    ds_read_b64_tr_b16 a[30:31], v20 offset:36128
    v_mfma_f32_16x16x32_bf16 v[52:55], a[84:87], a[8:11], 0
    v_cvt_pk_bf16_f32 v134, v76, v77
    v_cvt_pk_bf16_f32 v135, v78, v79
    v_mfma_f32_16x16x32_bf16 v[56:59], a[80:83], a[12:15], 0
    s_waitcnt lgkmcnt(6)
    ds_read_b64_tr_b16 a[32:33], v21 offset:34848
    ds_read_b64_tr_b16 a[34:35], v21 offset:36128
    v_mfma_f32_16x16x32_bf16 v[60:63], a[84:87], a[12:15], 0
    buffer_load_dwordx4 v3, s[48:51], s67 offen offset:1024  lds
    v_cvt_pk_bf16_f32 v136, v80, v81
    v_cvt_pk_bf16_f32 v137, v82, v83
    v_mfma_f32_16x16x32_bf16 v[64:67], a[80:83], a[16:19], 0
    s_waitcnt lgkmcnt(6)
    ds_read_b64_tr_b16 a[36:37], v20 offset:34880
    ds_read_b64_tr_b16 a[38:39], v20 offset:36160
    v_mfma_f32_16x16x32_bf16 v[68:71], a[84:87], a[16:19], 0
    v_cvt_pk_bf16_f32 v138, v84, v85
    v_cvt_pk_bf16_f32 v139, v86, v87
    buffer_load_dwordx4 v4, s[48:51], s67 offen offset:2048  lds
    v_cvt_pk_bf16_f32 v140, v88, v89
    v_cvt_pk_bf16_f32 v141, v90, v91
    v_mfma_f32_16x16x32_bf16 v[32:35], a[88:91], a[20:23], v[32:35]
    s_waitcnt lgkmcnt(6)
    ds_read_b64_tr_b16 a[0:1], v21 offset:24640
    ds_read_b64_tr_b16 a[2:3], v21 offset:25920
    v_mfma_f32_16x16x32_bf16 v[36:39], a[92:95], a[20:23], v[36:39]
    v_mfma_f32_16x16x32_bf16 v[40:43], a[88:91], a[24:27], v[40:43]
    s_waitcnt lgkmcnt(6)
    ds_read_b64_tr_b16 a[4:5], v20 offset:24672
    ds_read_b64_tr_b16 a[6:7], v20 offset:25952
    v_mfma_f32_16x16x32_bf16 v[44:47], a[92:95], a[24:27], v[44:47]
    s_add_u32 m0, s12, 27648
    s_nop 0
    buffer_load_dwordx4 v5, s[48:51], s67 offen offset:0  lds
    v_cvt_pk_bf16_f32 v142, v92, v93
    v_cvt_pk_bf16_f32 v143, v94, v95
    v_mfma_f32_16x16x32_bf16 v[48:51], a[88:91], a[28:31], v[48:51]
    s_waitcnt lgkmcnt(6)
    ds_read_b64_tr_b16 a[8:9], v21 offset:24672
    ds_read_b64_tr_b16 a[10:11], v21 offset:25952
    v_mfma_f32_16x16x32_bf16 v[52:55], a[92:95], a[28:31], v[52:55]
    v_cvt_pk_bf16_f32 v144, v96, v97
    v_cvt_pk_bf16_f32 v145, v98, v99
    v_mfma_f32_16x16x32_bf16 v[56:59], a[88:91], a[32:35], v[56:59]
    s_waitcnt lgkmcnt(6)
    ds_read_b64_tr_b16 a[12:13], v20 offset:24704
    ds_read_b64_tr_b16 a[14:15], v20 offset:25984
    v_mfma_f32_16x16x32_bf16 v[60:63], a[92:95], a[32:35], v[60:63]
    buffer_load_dwordx4 v6, s[48:51], s67 offen offset:1024  lds
    v_cvt_pk_bf16_f32 v146, v100, v101
    v_cvt_pk_bf16_f32 v147, v102, v103
    v_mfma_f32_16x16x32_bf16 v[64:67], a[88:91], a[36:39], v[64:67]
    s_waitcnt lgkmcnt(6)
    ds_read_b64_tr_b16 a[16:17], v21 offset:24704
    ds_read_b64_tr_b16 a[18:19], v21 offset:25984
    v_mfma_f32_16x16x32_bf16 v[68:71], a[92:95], a[36:39], v[68:71]
    v_cvt_pk_bf16_f32 v148, v104, v105
    v_cvt_pk_bf16_f32 v149, v106, v107
    s_add_u32 m0, s8, 8192
    s_add_u32 s64, s26, 24576
    buffer_load_dwordx4 v8, s[40:43], s64 offen offset:0  lds
    v_cvt_pk_bf16_f32 v150, v108, v109
    v_cvt_pk_bf16_f32 v151, v110, v111
    v_mfma_f32_16x16x32_bf16 v[72:75], a[80:83], a[0:3], 0
    s_waitcnt lgkmcnt(6)
    ds_read_b64_tr_b16 a[20:21], v21 offset:34880
    ds_read_b64_tr_b16 a[22:23], v21 offset:36160
    v_mfma_f32_16x16x32_bf16 v[76:79], a[84:87], a[0:3], 0
    v_mfma_f32_16x16x32_bf16 v[80:83], a[80:83], a[4:7], 0
    s_waitcnt lgkmcnt(6)
    ds_read_b64_tr_b16 a[24:25], v20 offset:34912
    ds_read_b64_tr_b16 a[26:27], v20 offset:36192
    v_mfma_f32_16x16x32_bf16 v[84:87], a[84:87], a[4:7], 0
    buffer_load_dwordx4 v9, s[40:43], s64 offen offset:1024  lds
    v_mfma_f32_16x16x32_bf16 v[88:91], a[80:83], a[8:11], 0
    s_waitcnt lgkmcnt(6)
    ds_read_b64_tr_b16 a[28:29], v21 offset:34912
    ds_read_b64_tr_b16 a[30:31], v21 offset:36192
    v_mfma_f32_16x16x32_bf16 v[92:95], a[84:87], a[8:11], 0
    v_accvgpr_write_b32 a96, v112
    v_accvgpr_write_b32 a97, v113
    v_mfma_f32_16x16x32_bf16 v[96:99], a[80:83], a[12:15], 0
    s_waitcnt lgkmcnt(6)
    ds_read_b64_tr_b16 a[32:33], v20 offset:34944
    ds_read_b64_tr_b16 a[34:35], v20 offset:36224
    v_mfma_f32_16x16x32_bf16 v[100:103], a[84:87], a[12:15], 0
    buffer_load_dwordx4 v10, s[40:43], s64 offen offset:2048  lds
    v_accvgpr_write_b32 a98, v114
    v_accvgpr_write_b32 a99, v115
    v_mfma_f32_16x16x32_bf16 v[104:107], a[80:83], a[16:19], 0
    s_waitcnt lgkmcnt(6)
    ds_read_b64_tr_b16 a[36:37], v21 offset:34944
    ds_read_b64_tr_b16 a[38:39], v21 offset:36224
    v_mfma_f32_16x16x32_bf16 v[108:111], a[84:87], a[16:19], 0
    buffer_load_dwordx4 v11, s[40:43], s64 offen offset:3072  lds
    v_accvgpr_write_b32 a100, v116
    v_mfma_f32_16x16x32_bf16 v[72:75], a[88:91], a[20:23], v[72:75]
    s_waitcnt vmcnt(13)
    s_barrier
    s_waitcnt lgkmcnt(6)
    ds_read_b128 a[64:67], v16 offset:0
    ds_read_b128 a[68:71], v16 offset:2048
    v_mfma_f32_16x16x32_bf16 v[76:79], a[92:95], a[20:23], v[76:79]
    ds_read_b128 a[72:75], v17 offset:0
    v_mfma_f32_16x16x32_bf16 v[80:83], a[88:91], a[24:27], v[80:83]
    s_waitcnt lgkmcnt(7)
    ds_read_b128 a[76:79], v17 offset:2048
    ds_read_b64_tr_b16 a[0:1], v18 offset:0
    v_mfma_f32_16x16x32_bf16 v[84:87], a[92:95], a[24:27], v[84:87]
    ds_read_b64_tr_b16 a[2:3], v18 offset:1280
    v_mfma_f32_16x16x32_bf16 v[88:91], a[88:91], a[28:31], v[88:91]
    s_waitcnt lgkmcnt(8)
    ds_read_b64_tr_b16 a[4:5], v19 offset:0
    ds_read_b64_tr_b16 a[6:7], v19 offset:1280
    v_mfma_f32_16x16x32_bf16 v[92:95], a[92:95], a[28:31], v[92:95]
    ds_read_b64_tr_b16 a[8:9], v18 offset:32
    v_accvgpr_write_b32 a101, v117
    v_accvgpr_write_b32 a102, v118
    s_add_u32 m0, s12, 49152
    s_add_u32 s65, s20, 491520
    buffer_load_dwordx4 v2, s[48:51], s65 offen offset:0  lds
    v_mfma_f32_16x16x32_bf16 v[96:99], a[88:91], a[32:35], v[96:99]
    s_waitcnt lgkmcnt(9)
    ds_read_b64_tr_b16 a[10:11], v18 offset:1312
    ds_read_b64_tr_b16 a[12:13], v19 offset:32
    v_mfma_f32_16x16x32_bf16 v[100:103], a[92:95], a[32:35], v[100:103]
    ds_read_b64_tr_b16 a[14:15], v19 offset:1312
    v_accvgpr_write_b32 a103, v119
    v_accvgpr_write_b32 a104, v120
    v_mfma_f32_16x16x32_bf16 v[104:107], a[88:91], a[36:39], v[104:107]
    s_waitcnt lgkmcnt(6)
    ds_read_b64_tr_b16 a[16:17], v18 offset:64
    ds_read_b64_tr_b16 a[18:19], v18 offset:1344
    v_mfma_f32_16x16x32_bf16 v[108:111], a[92:95], a[36:39], v[108:111]
    buffer_load_dwordx4 v3, s[48:51], s65 offen offset:1024  lds
    v_accvgpr_write_b32 a105, v121
    v_mfma_f32_16x16x32_bf16 v[32:35], a[64:67], a[0:3], v[32:35]
    s_waitcnt lgkmcnt(6)
    ds_read_b64_tr_b16 a[20:21], v19 offset:64
    ds_read_b64_tr_b16 a[22:23], v19 offset:1344
    v_mfma_f32_16x16x32_bf16 v[36:39], a[68:71], a[0:3], v[36:39]
    v_mfma_f32_16x16x32_bf16 v[40:43], a[64:67], a[4:7], v[40:43]
    s_waitcnt lgkmcnt(6)
    ds_read_b64_tr_b16 a[24:25], v18 offset:96
    ds_read_b64_tr_b16 a[26:27], v18 offset:1376
    v_mfma_f32_16x16x32_bf16 v[44:47], a[68:71], a[4:7], v[44:47]
    v_mfma_f32_16x16x32_bf16 v[48:51], a[64:67], a[8:11], v[48:51]
    s_waitcnt lgkmcnt(6)
    ds_read_b64_tr_b16 a[28:29], v19 offset:96
    ds_read_b64_tr_b16 a[30:31], v19 offset:1376
    v_mfma_f32_16x16x32_bf16 v[52:55], a[68:71], a[8:11], v[52:55]
    v_accvgpr_write_b32 a106, v122
    v_accvgpr_write_b32 a107, v123
    v_mfma_f32_16x16x32_bf16 v[56:59], a[64:67], a[12:15], v[56:59]
    s_waitcnt lgkmcnt(6)
    ds_read_b64_tr_b16 a[32:33], v18 offset:128
    ds_read_b64_tr_b16 a[34:35], v18 offset:1408
    v_mfma_f32_16x16x32_bf16 v[60:63], a[68:71], a[12:15], v[60:63]
    v_mfma_f32_16x16x32_bf16 v[64:67], a[64:67], a[16:19], v[64:67]
    s_waitcnt lgkmcnt(6)
    ds_read_b64_tr_b16 a[36:37], v19 offset:128
    ds_read_b64_tr_b16 a[38:39], v19 offset:1408
    v_mfma_f32_16x16x32_bf16 v[68:71], a[68:71], a[16:19], v[68:71]
    v_accvgpr_write_b32 a108, v124
    v_accvgpr_write_b32 a109, v125
    buffer_load_dwordx4 v4, s[48:51], s65 offen offset:2048  lds
    v_accvgpr_write_b32 a110, v126
    v_mfma_f32_16x16x32_bf16 v[72:75], a[64:67], a[20:23], v[72:75]
    s_waitcnt lgkmcnt(6)
    ds_read_b64_tr_b16 a[0:1], v18 offset:10240
    ds_read_b64_tr_b16 a[2:3], v18 offset:11520
    v_mfma_f32_16x16x32_bf16 v[76:79], a[68:71], a[20:23], v[76:79]
    v_mfma_f32_16x16x32_bf16 v[80:83], a[64:67], a[24:27], v[80:83]
    s_waitcnt lgkmcnt(6)
    ds_read_b64_tr_b16 a[4:5], v19 offset:10240
    ds_read_b64_tr_b16 a[6:7], v19 offset:11520
    v_mfma_f32_16x16x32_bf16 v[84:87], a[68:71], a[24:27], v[84:87]
    v_mfma_f32_16x16x32_bf16 v[88:91], a[64:67], a[28:31], v[88:91]
    s_waitcnt lgkmcnt(6)
    ds_read_b64_tr_b16 a[8:9], v18 offset:10272
    ds_read_b64_tr_b16 a[10:11], v18 offset:11552
    v_mfma_f32_16x16x32_bf16 v[92:95], a[68:71], a[28:31], v[92:95]
    v_accvgpr_write_b32 a111, v127
    v_accvgpr_write_b32 a112, v128
    v_mfma_f32_16x16x32_bf16 v[96:99], a[64:67], a[32:35], v[96:99]
    s_waitcnt lgkmcnt(6)
    ds_read_b64_tr_b16 a[12:13], v19 offset:10272
    ds_read_b64_tr_b16 a[14:15], v19 offset:11552
    v_mfma_f32_16x16x32_bf16 v[100:103], a[68:71], a[32:35], v[100:103]
    v_mfma_f32_16x16x32_bf16 v[104:107], a[64:67], a[36:39], v[104:107]
    s_waitcnt lgkmcnt(6)
    ds_read_b64_tr_b16 a[16:17], v18 offset:10304
    ds_read_b64_tr_b16 a[18:19], v18 offset:11584
    v_mfma_f32_16x16x32_bf16 v[108:111], a[68:71], a[36:39], v[108:111]
    v_accvgpr_write_b32 a113, v129
    v_accvgpr_write_b32 a114, v130
    s_add_u32 m0, s12, 52224
    s_nop 0
    buffer_load_dwordx4 v5, s[48:51], s65 offen offset:0  lds
    v_accvgpr_write_b32 a115, v131
    v_mfma_f32_16x16x32_bf16 v[32:35], a[72:75], a[0:3], v[32:35]
    s_waitcnt lgkmcnt(6)
    ds_read_b64_tr_b16 a[20:21], v19 offset:10304
    ds_read_b64_tr_b16 a[22:23], v19 offset:11584
    v_mfma_f32_16x16x32_bf16 v[36:39], a[76:79], a[0:3], v[36:39]
    v_mfma_f32_16x16x32_bf16 v[40:43], a[72:75], a[4:7], v[40:43]
    s_waitcnt lgkmcnt(6)
    ds_read_b64_tr_b16 a[24:25], v18 offset:10336
    ds_read_b64_tr_b16 a[26:27], v18 offset:11616
    v_mfma_f32_16x16x32_bf16 v[44:47], a[76:79], a[4:7], v[44:47]
    v_mfma_f32_16x16x32_bf16 v[48:51], a[72:75], a[8:11], v[48:51]
    s_waitcnt lgkmcnt(6)
    ds_read_b64_tr_b16 a[28:29], v19 offset:10336
    ds_read_b64_tr_b16 a[30:31], v19 offset:11616
    v_mfma_f32_16x16x32_bf16 v[52:55], a[76:79], a[8:11], v[52:55]
    v_accvgpr_write_b32 a116, v132
    v_accvgpr_write_b32 a117, v133
    v_mfma_f32_16x16x32_bf16 v[56:59], a[72:75], a[12:15], v[56:59]
    s_waitcnt lgkmcnt(6)
    ds_read_b64_tr_b16 a[32:33], v18 offset:10368
    ds_read_b64_tr_b16 a[34:35], v18 offset:11648
    v_mfma_f32_16x16x32_bf16 v[60:63], a[76:79], a[12:15], v[60:63]
    v_mfma_f32_16x16x32_bf16 v[64:67], a[72:75], a[16:19], v[64:67]
    s_waitcnt lgkmcnt(6)
    ds_read_b64_tr_b16 a[36:37], v19 offset:10368
    ds_read_b64_tr_b16 a[38:39], v19 offset:11648
    v_mfma_f32_16x16x32_bf16 v[68:71], a[76:79], a[16:19], v[68:71]
    v_accvgpr_write_b32 a118, v134
    v_accvgpr_write_b32 a119, v135
    buffer_load_dwordx4 v6, s[48:51], s65 offen offset:1024  lds
    v_accvgpr_write_b32 a120, v136
    v_mfma_f32_16x16x32_bf16 v[72:75], a[72:75], a[20:23], v[72:75]
    s_waitcnt vmcnt(9)
    s_barrier
    s_waitcnt lgkmcnt(6)
    ds_read_b128 a[80:83], v16 offset:4096
    ds_read_b128 a[84:87], v16 offset:6144
    v_mfma_f32_16x16x32_bf16 v[76:79], a[76:79], a[20:23], v[76:79]
    ds_read_b128 a[88:91], v17 offset:4096
    v_mfma_f32_16x16x32_bf16 v[80:83], a[72:75], a[24:27], v[80:83]
    s_waitcnt lgkmcnt(7)
    ds_read_b128 a[92:95], v17 offset:6144
    ds_read_b64_tr_b16 a[0:1], v18 offset:24576
    v_mfma_f32_16x16x32_bf16 v[84:87], a[76:79], a[24:27], v[84:87]
    ds_read_b64_tr_b16 a[2:3], v18 offset:25856
    s_add_u32 m0, s8, 12288
    s_add_u32 s66, s27, 24576
    buffer_load_dwordx4 v8, s[40:43], s66 offen offset:0  lds
    v_mfma_f32_16x16x32_bf16 v[88:91], a[72:75], a[28:31], v[88:91]
    s_waitcnt lgkmcnt(8)
    ds_read_b64_tr_b16 a[4:5], v19 offset:24576
    ds_read_b64_tr_b16 a[6:7], v19 offset:25856
    v_mfma_f32_16x16x32_bf16 v[92:95], a[76:79], a[28:31], v[92:95]
    ds_read_b64_tr_b16 a[8:9], v18 offset:24608
    v_accvgpr_write_b32 a121, v137
    v_accvgpr_write_b32 a122, v138
    buffer_load_dwordx4 v9, s[40:43], s66 offen offset:1024  lds
    v_mfma_f32_16x16x32_bf16 v[96:99], a[72:75], a[32:35], v[96:99]
    s_waitcnt lgkmcnt(9)
    ds_read_b64_tr_b16 a[10:11], v18 offset:25888
    ds_read_b64_tr_b16 a[12:13], v19 offset:24608
    v_mfma_f32_16x16x32_bf16 v[100:103], a[76:79], a[32:35], v[100:103]
    ds_read_b64_tr_b16 a[14:15], v19 offset:25888
    buffer_load_dwordx4 v10, s[40:43], s66 offen offset:2048  lds
    v_accvgpr_write_b32 a123, v139
    v_accvgpr_write_b32 a124, v140
    v_mfma_f32_16x16x32_bf16 v[104:107], a[72:75], a[36:39], v[104:107]
    s_waitcnt lgkmcnt(6)
    ds_read_b64_tr_b16 a[16:17], v18 offset:24640
    ds_read_b64_tr_b16 a[18:19], v18 offset:25920
    v_mfma_f32_16x16x32_bf16 v[108:111], a[76:79], a[36:39], v[108:111]
    buffer_load_dwordx4 v11, s[40:43], s66 offen offset:3072  lds
    v_accvgpr_write_b32 a125, v141
    v_mfma_f32_16x16x32_bf16 v[32:35], a[80:83], a[0:3], v[32:35]
    s_waitcnt lgkmcnt(6)
    ds_read_b64_tr_b16 a[20:21], v18 offset:34816
    ds_read_b64_tr_b16 a[22:23], v18 offset:36096
    v_mfma_f32_16x16x32_bf16 v[36:39], a[84:87], a[0:3], v[36:39]
    v_mfma_f32_16x16x32_bf16 v[40:43], a[80:83], a[4:7], v[40:43]
    s_waitcnt lgkmcnt(6)
    ds_read_b64_tr_b16 a[24:25], v19 offset:34816
    ds_read_b64_tr_b16 a[26:27], v19 offset:36096
    v_mfma_f32_16x16x32_bf16 v[44:47], a[84:87], a[4:7], v[44:47]
    s_add_u32 m0, s12, 73728
    s_add_u32 s67, s21, 491520
    buffer_load_dwordx4 v2, s[48:51], s67 offen offset:0  lds
    v_mfma_f32_16x16x32_bf16 v[48:51], a[80:83], a[8:11], v[48:51]
    s_waitcnt lgkmcnt(6)
    ds_read_b64_tr_b16 a[28:29], v18 offset:34848
    ds_read_b64_tr_b16 a[30:31], v18 offset:36128
    v_mfma_f32_16x16x32_bf16 v[52:55], a[84:87], a[8:11], v[52:55]
    v_accvgpr_write_b32 a126, v142
    v_accvgpr_write_b32 a127, v143
    v_mfma_f32_16x16x32_bf16 v[56:59], a[80:83], a[12:15], v[56:59]
    s_waitcnt lgkmcnt(6)
    ds_read_b64_tr_b16 a[32:33], v19 offset:34848
    ds_read_b64_tr_b16 a[34:35], v19 offset:36128
    v_mfma_f32_16x16x32_bf16 v[60:63], a[84:87], a[12:15], v[60:63]
    buffer_load_dwordx4 v3, s[48:51], s67 offen offset:1024  lds
    v_accvgpr_write_b32 a128, v144
    v_accvgpr_write_b32 a129, v145
    v_mfma_f32_16x16x32_bf16 v[64:67], a[80:83], a[16:19], v[64:67]
    s_waitcnt lgkmcnt(6)
    ds_read_b64_tr_b16 a[36:37], v18 offset:34880
    ds_read_b64_tr_b16 a[38:39], v18 offset:36160
    v_mfma_f32_16x16x32_bf16 v[68:71], a[84:87], a[16:19], v[68:71]
    buffer_load_dwordx4 v4, s[48:51], s67 offen offset:2048  lds
    v_accvgpr_write_b32 a130, v146
    v_mfma_f32_16x16x32_bf16 v[32:35], a[88:91], a[20:23], v[32:35]
    s_waitcnt lgkmcnt(6)
    ds_read_b64_tr_b16 a[0:1], v19 offset:24640
    ds_read_b64_tr_b16 a[2:3], v19 offset:25920
    v_mfma_f32_16x16x32_bf16 v[36:39], a[92:95], a[20:23], v[36:39]
    v_mfma_f32_16x16x32_bf16 v[40:43], a[88:91], a[24:27], v[40:43]
    s_waitcnt lgkmcnt(6)
    ds_read_b64_tr_b16 a[4:5], v18 offset:24672
    ds_read_b64_tr_b16 a[6:7], v18 offset:25952
    v_mfma_f32_16x16x32_bf16 v[44:47], a[92:95], a[24:27], v[44:47]
    s_add_u32 m0, s12, 76800
    s_nop 0
    buffer_load_dwordx4 v5, s[48:51], s67 offen offset:0  lds
    v_mfma_f32_16x16x32_bf16 v[48:51], a[88:91], a[28:31], v[48:51]
    s_waitcnt lgkmcnt(6)
    ds_read_b64_tr_b16 a[8:9], v19 offset:24672
    ds_read_b64_tr_b16 a[10:11], v19 offset:25952
    v_mfma_f32_16x16x32_bf16 v[52:55], a[92:95], a[28:31], v[52:55]
    v_accvgpr_write_b32 a131, v147
    v_accvgpr_write_b32 a132, v148
    v_mfma_f32_16x16x32_bf16 v[56:59], a[88:91], a[32:35], v[56:59]
    s_waitcnt lgkmcnt(6)
    ds_read_b64_tr_b16 a[12:13], v18 offset:24704
    ds_read_b64_tr_b16 a[14:15], v18 offset:25984
    v_mfma_f32_16x16x32_bf16 v[60:63], a[92:95], a[32:35], v[60:63]
    buffer_load_dwordx4 v6, s[48:51], s67 offen offset:1024  lds
    v_accvgpr_write_b32 a133, v149
    v_accvgpr_write_b32 a134, v150
    v_mfma_f32_16x16x32_bf16 v[64:67], a[88:91], a[36:39], v[64:67]
    s_waitcnt lgkmcnt(6)
    ds_read_b64_tr_b16 a[16:17], v19 offset:24704
    ds_read_b64_tr_b16 a[18:19], v19 offset:25984
    v_mfma_f32_16x16x32_bf16 v[68:71], a[92:95], a[36:39], v[68:71]
    s_add_u32 m0, s8, 0
    s_add_u32 s64, s28, 24576
    buffer_load_dwordx4 v8, s[40:43], s64 offen offset:0  lds
    v_accvgpr_write_b32 a135, v151
    v_mfma_f32_16x16x32_bf16 v[72:75], a[80:83], a[0:3], v[72:75]
    s_waitcnt lgkmcnt(6)
    ds_read_b64_tr_b16 a[20:21], v19 offset:34880
    ds_read_b64_tr_b16 a[22:23], v19 offset:36160
    v_mfma_f32_16x16x32_bf16 v[76:79], a[84:87], a[0:3], v[76:79]
    ds_read_b64_tr_b16 a[24:25], v18 offset:34912
    ds_read_b64_tr_b16 a[26:27], v18 offset:36192
    v_mfma_f32_16x16x32_bf16 v[80:83], a[80:83], a[4:7], v[80:83]
    s_waitcnt lgkmcnt(8)
    ds_read_b64_tr_b16 a[28:29], v19 offset:34912
    ds_read_b64_tr_b16 a[30:31], v19 offset:36192
    v_mfma_f32_16x16x32_bf16 v[84:87], a[84:87], a[4:7], v[84:87]
    ds_read_b64_tr_b16 a[32:33], v18 offset:34944
    ds_read_b64_tr_b16 a[34:35], v18 offset:36224
    buffer_load_dwordx4 v9, s[40:43], s64 offen offset:1024  lds
    v_cvt_pk_bf16_f32 v112, v32, v33
    v_cvt_pk_bf16_f32 v113, v34, v35
    v_mfma_f32_16x16x32_bf16 v[88:91], a[80:83], a[8:11], v[88:91]
    s_waitcnt lgkmcnt(10)
    ds_read_b64_tr_b16 a[36:37], v19 offset:34944
    ds_read_b64_tr_b16 a[38:39], v19 offset:36224
    v_mfma_f32_16x16x32_bf16 v[92:95], a[84:87], a[8:11], v[92:95]
    v_cvt_pk_bf16_f32 v114, v36, v37
    v_cvt_pk_bf16_f32 v115, v38, v39
    v_mfma_f32_16x16x32_bf16 v[96:99], a[80:83], a[12:15], v[96:99]
    s_waitcnt lgkmcnt(10)
    v_mfma_f32_16x16x32_bf16 v[100:103], a[84:87], a[12:15], v[100:103]
    buffer_load_dwordx4 v10, s[40:43], s64 offen offset:2048  lds
    v_cvt_pk_bf16_f32 v116, v40, v41
    v_cvt_pk_bf16_f32 v117, v42, v43
    v_mfma_f32_16x16x32_bf16 v[104:107], a[80:83], a[16:19], v[104:107]
    s_waitcnt lgkmcnt(8)
    v_mfma_f32_16x16x32_bf16 v[108:111], a[84:87], a[16:19], v[108:111]
    v_cvt_pk_bf16_f32 v118, v44, v45
    v_cvt_pk_bf16_f32 v119, v46, v47
    buffer_load_dwordx4 v11, s[40:43], s64 offen offset:3072  lds
    v_cvt_pk_bf16_f32 v120, v48, v49
    v_cvt_pk_bf16_f32 v121, v50, v51
    v_mfma_f32_16x16x32_bf16 v[72:75], a[88:91], a[20:23], v[72:75]
    s_waitcnt lgkmcnt(0)
    s_waitcnt vmcnt(13)
    s_barrier
    ds_read_b128 a[64:67], v16 offset:8192
    ds_read_b128 a[68:71], v16 offset:10240
    v_mfma_f32_16x16x32_bf16 v[76:79], a[92:95], a[20:23], v[76:79]
    ds_read_b128 a[72:75], v17 offset:8192
    v_mfma_f32_16x16x32_bf16 v[80:83], a[88:91], a[24:27], v[80:83]
    ds_read_b128 a[76:79], v17 offset:10240
    ds_read_b64_tr_b16 a[0:1], v20 offset:0
    v_mfma_f32_16x16x32_bf16 v[84:87], a[92:95], a[24:27], v[84:87]
    ds_read_b64_tr_b16 a[2:3], v20 offset:1280
    s_add_u32 m0, s12, 0
    s_add_u32 s65, s22, 491520
    buffer_load_dwordx4 v2, s[48:51], s65 offen offset:0  lds
    v_cvt_pk_bf16_f32 v122, v52, v53
    v_cvt_pk_bf16_f32 v123, v54, v55
    v_mfma_f32_16x16x32_bf16 v[88:91], a[88:91], a[28:31], v[88:91]
    ds_read_b64_tr_b16 a[4:5], v21 offset:0
    ds_read_b64_tr_b16 a[6:7], v21 offset:1280
    v_mfma_f32_16x16x32_bf16 v[92:95], a[92:95], a[28:31], v[92:95]
    ds_read_b64_tr_b16 a[8:9], v20 offset:32
    buffer_load_dwordx4 v3, s[48:51], s65 offen offset:1024  lds
    v_cvt_pk_bf16_f32 v124, v56, v57
    v_cvt_pk_bf16_f32 v125, v58, v59
    v_mfma_f32_16x16x32_bf16 v[96:99], a[88:91], a[32:35], v[96:99]
    ds_read_b64_tr_b16 a[10:11], v20 offset:1312
    ds_read_b64_tr_b16 a[12:13], v21 offset:32
    v_mfma_f32_16x16x32_bf16 v[100:103], a[92:95], a[32:35], v[100:103]
    ds_read_b64_tr_b16 a[14:15], v21 offset:1312
    v_cvt_pk_bf16_f32 v126, v60, v61
    v_cvt_pk_bf16_f32 v127, v62, v63
    buffer_load_dwordx4 v4, s[48:51], s65 offen offset:2048  lds
    v_mfma_f32_16x16x32_bf16 v[104:107], a[88:91], a[36:39], v[104:107]
    s_waitcnt lgkmcnt(6)
    ds_read_b64_tr_b16 a[16:17], v20 offset:64
    ds_read_b64_tr_b16 a[18:19], v20 offset:1344
    v_mfma_f32_16x16x32_bf16 v[108:111], a[92:95], a[36:39], v[108:111]
    v_cvt_pk_bf16_f32 v128, v64, v65
    v_cvt_pk_bf16_f32 v129, v66, v67
    s_add_u32 m0, s12, 3072
    s_nop 0
    buffer_load_dwordx4 v5, s[48:51], s65 offen offset:0  lds
    v_cvt_pk_bf16_f32 v130, v68, v69
    v_cvt_pk_bf16_f32 v131, v70, v71
    v_mfma_f32_16x16x32_bf16 v[32:35], a[64:67], a[0:3], 0
    s_waitcnt lgkmcnt(6)
    ds_read_b64_tr_b16 a[20:21], v20 offset:10240
    ds_read_b64_tr_b16 a[22:23], v20 offset:11520
    v_mfma_f32_16x16x32_bf16 v[36:39], a[68:71], a[0:3], 0
    v_mfma_f32_16x16x32_bf16 v[40:43], a[64:67], a[4:7], 0
    s_waitcnt lgkmcnt(6)
    ds_read_b64_tr_b16 a[24:25], v21 offset:10240
    ds_read_b64_tr_b16 a[26:27], v21 offset:11520
    v_mfma_f32_16x16x32_bf16 v[44:47], a[68:71], a[4:7], 0
    buffer_load_dwordx4 v6, s[48:51], s65 offen offset:1024  lds
    v_cvt_pk_bf16_f32 v132, v72, v73
    v_cvt_pk_bf16_f32 v133, v74, v75
    v_mfma_f32_16x16x32_bf16 v[48:51], a[64:67], a[8:11], 0
    s_waitcnt lgkmcnt(6)
    ds_read_b64_tr_b16 a[28:29], v20 offset:10272
    ds_read_b64_tr_b16 a[30:31], v20 offset:11552
    v_mfma_f32_16x16x32_bf16 v[52:55], a[68:71], a[8:11], 0
    s_add_u32 m0, s8, 4096
    s_add_u32 s66, s26, 36864
    buffer_load_dwordx4 v8, s[40:43], s66 offen offset:0  lds
    v_cvt_pk_bf16_f32 v134, v76, v77
    v_cvt_pk_bf16_f32 v135, v78, v79
    v_mfma_f32_16x16x32_bf16 v[56:59], a[64:67], a[12:15], 0
    s_waitcnt lgkmcnt(6)
    ds_read_b64_tr_b16 a[32:33], v21 offset:10272
    ds_read_b64_tr_b16 a[34:35], v21 offset:11552
    v_mfma_f32_16x16x32_bf16 v[60:63], a[68:71], a[12:15], 0
    v_cvt_pk_bf16_f32 v136, v80, v81
    v_cvt_pk_bf16_f32 v137, v82, v83
    buffer_load_dwordx4 v9, s[40:43], s66 offen offset:1024  lds
    v_mfma_f32_16x16x32_bf16 v[64:67], a[64:67], a[16:19], 0
    s_waitcnt lgkmcnt(6)
    ds_read_b64_tr_b16 a[36:37], v20 offset:10304
    ds_read_b64_tr_b16 a[38:39], v20 offset:11584
    v_mfma_f32_16x16x32_bf16 v[68:71], a[68:71], a[16:19], 0
    v_cvt_pk_bf16_f32 v138, v84, v85
    v_cvt_pk_bf16_f32 v139, v86, v87
    buffer_load_dwordx4 v10, s[40:43], s66 offen offset:2048  lds
    v_cvt_pk_bf16_f32 v140, v88, v89
    v_cvt_pk_bf16_f32 v141, v90, v91
    v_mfma_f32_16x16x32_bf16 v[32:35], a[72:75], a[20:23], v[32:35]
    s_waitcnt lgkmcnt(6)
    ds_read_b64_tr_b16 a[0:1], v21 offset:64
    ds_read_b64_tr_b16 a[2:3], v21 offset:1344
    v_mfma_f32_16x16x32_bf16 v[36:39], a[76:79], a[20:23], v[36:39]
    v_mfma_f32_16x16x32_bf16 v[40:43], a[72:75], a[24:27], v[40:43]
    s_waitcnt lgkmcnt(6)
    ds_read_b64_tr_b16 a[4:5], v20 offset:96
    ds_read_b64_tr_b16 a[6:7], v20 offset:1376
    v_mfma_f32_16x16x32_bf16 v[44:47], a[76:79], a[24:27], v[44:47]
    buffer_load_dwordx4 v11, s[40:43], s66 offen offset:3072  lds
    v_cvt_pk_bf16_f32 v142, v92, v93
    v_cvt_pk_bf16_f32 v143, v94, v95
    v_mfma_f32_16x16x32_bf16 v[48:51], a[72:75], a[28:31], v[48:51]
    s_waitcnt lgkmcnt(6)
    ds_read_b64_tr_b16 a[8:9], v21 offset:96
    ds_read_b64_tr_b16 a[10:11], v21 offset:1376
    v_mfma_f32_16x16x32_bf16 v[52:55], a[76:79], a[28:31], v[52:55]
    v_cvt_pk_bf16_f32 v144, v96, v97
    v_cvt_pk_bf16_f32 v145, v98, v99
    v_mfma_f32_16x16x32_bf16 v[56:59], a[72:75], a[32:35], v[56:59]
    s_waitcnt lgkmcnt(6)
    ds_read_b64_tr_b16 a[12:13], v20 offset:128
    ds_read_b64_tr_b16 a[14:15], v20 offset:1408
    v_mfma_f32_16x16x32_bf16 v[60:63], a[76:79], a[32:35], v[60:63]
    s_add_u32 m0, s12, 24576
    s_add_u32 s67, s20, 737280
    buffer_load_dwordx4 v2, s[48:51], s67 offen offset:0  lds
    v_cvt_pk_bf16_f32 v146, v100, v101
    v_cvt_pk_bf16_f32 v147, v102, v103
    v_mfma_f32_16x16x32_bf16 v[64:67], a[72:75], a[36:39], v[64:67]
    s_waitcnt lgkmcnt(6)
    ds_read_b64_tr_b16 a[16:17], v21 offset:128
    ds_read_b64_tr_b16 a[18:19], v21 offset:1408
    v_mfma_f32_16x16x32_bf16 v[68:71], a[76:79], a[36:39], v[68:71]
    v_cvt_pk_bf16_f32 v148, v104, v105
    v_cvt_pk_bf16_f32 v149, v106, v107
    buffer_load_dwordx4 v3, s[48:51], s67 offen offset:1024  lds
    v_cvt_pk_bf16_f32 v150, v108, v109
    v_cvt_pk_bf16_f32 v151, v110, v111
    v_mfma_f32_16x16x32_bf16 v[72:75], a[64:67], a[0:3], 0
    s_waitcnt lgkmcnt(6)
    ds_read_b64_tr_b16 a[20:21], v21 offset:10304
    ds_read_b64_tr_b16 a[22:23], v21 offset:11584
    v_mfma_f32_16x16x32_bf16 v[76:79], a[68:71], a[0:3], 0
    v_mfma_f32_16x16x32_bf16 v[80:83], a[64:67], a[4:7], 0
    s_waitcnt lgkmcnt(6)
    ds_read_b64_tr_b16 a[24:25], v20 offset:10336
    ds_read_b64_tr_b16 a[26:27], v20 offset:11616
    v_mfma_f32_16x16x32_bf16 v[84:87], a[68:71], a[4:7], 0
    buffer_load_dwordx4 v4, s[48:51], s67 offen offset:2048  lds
    v_mfma_f32_16x16x32_bf16 v[88:91], a[64:67], a[8:11], 0
    s_waitcnt lgkmcnt(6)
    ds_read_b64_tr_b16 a[28:29], v21 offset:10336
    ds_read_b64_tr_b16 a[30:31], v21 offset:11616
    v_mfma_f32_16x16x32_bf16 v[92:95], a[68:71], a[8:11], 0
    v_mfma_f32_16x16x32_bf16 v[96:99], a[64:67], a[12:15], 0
    s_waitcnt lgkmcnt(6)
    ds_read_b64_tr_b16 a[32:33], v20 offset:10368
    ds_read_b64_tr_b16 a[34:35], v20 offset:11648
    v_mfma_f32_16x16x32_bf16 v[100:103], a[68:71], a[12:15], 0
    s_add_u32 m0, s12, 27648
    s_nop 0
    buffer_load_dwordx4 v5, s[48:51], s67 offen offset:0  lds
    v_mfma_f32_16x16x32_bf16 v[104:107], a[64:67], a[16:19], 0
    s_waitcnt lgkmcnt(6)
    ds_read_b64_tr_b16 a[36:37], v21 offset:10368
    ds_read_b64_tr_b16 a[38:39], v21 offset:11648
    v_mfma_f32_16x16x32_bf16 v[108:111], a[68:71], a[16:19], 0
    buffer_load_dwordx4 v6, s[48:51], s67 offen offset:1024  lds
    v_mfma_f32_16x16x32_bf16 v[72:75], a[72:75], a[20:23], v[72:75]
    s_waitcnt vmcnt(18)
    s_barrier
    s_waitcnt lgkmcnt(6)
    ds_read_b128 a[80:83], v16 offset:12288
    ds_read_b128 a[84:87], v16 offset:14336
    v_mfma_f32_16x16x32_bf16 v[76:79], a[76:79], a[20:23], v[76:79]
    ds_read_b128 a[88:91], v17 offset:12288
    v_mfma_f32_16x16x32_bf16 v[80:83], a[72:75], a[24:27], v[80:83]
    s_waitcnt lgkmcnt(7)
    ds_read_b128 a[92:95], v17 offset:14336
    ds_read_b64_tr_b16 a[0:1], v20 offset:24576
    v_mfma_f32_16x16x32_bf16 v[84:87], a[76:79], a[24:27], v[84:87]
    ds_read_b64_tr_b16 a[2:3], v20 offset:25856
    v_mfma_f32_16x16x32_bf16 v[88:91], a[72:75], a[28:31], v[88:91]
    s_waitcnt lgkmcnt(8)
    ds_read_b64_tr_b16 a[4:5], v21 offset:24576
    ds_read_b64_tr_b16 a[6:7], v21 offset:25856
    v_mfma_f32_16x16x32_bf16 v[92:95], a[76:79], a[28:31], v[92:95]
    ds_read_b64_tr_b16 a[8:9], v20 offset:24608
    v_mfma_f32_16x16x32_bf16 v[96:99], a[72:75], a[32:35], v[96:99]
    s_waitcnt lgkmcnt(9)
    ds_read_b64_tr_b16 a[10:11], v20 offset:25888
    ds_read_b64_tr_b16 a[12:13], v21 offset:24608
    v_mfma_f32_16x16x32_bf16 v[100:103], a[76:79], a[32:35], v[100:103]
    ds_read_b64_tr_b16 a[14:15], v21 offset:25888
    v_mfma_f32_16x16x32_bf16 v[104:107], a[72:75], a[36:39], v[104:107]
    s_waitcnt lgkmcnt(6)
    ds_read_b64_tr_b16 a[16:17], v20 offset:24640
    ds_read_b64_tr_b16 a[18:19], v20 offset:25920
    v_mfma_f32_16x16x32_bf16 v[108:111], a[76:79], a[36:39], v[108:111]
    v_mfma_f32_16x16x32_bf16 v[32:35], a[80:83], a[0:3], v[32:35]
    s_waitcnt lgkmcnt(6)
    ds_read_b64_tr_b16 a[20:21], v21 offset:24640
    ds_read_b64_tr_b16 a[22:23], v21 offset:25920
    v_mfma_f32_16x16x32_bf16 v[36:39], a[84:87], a[0:3], v[36:39]
    v_mfma_f32_16x16x32_bf16 v[40:43], a[80:83], a[4:7], v[40:43]
    s_waitcnt lgkmcnt(6)
    ds_read_b64_tr_b16 a[24:25], v20 offset:24672
    ds_read_b64_tr_b16 a[26:27], v20 offset:25952
    v_mfma_f32_16x16x32_bf16 v[44:47], a[84:87], a[4:7], v[44:47]
    v_mfma_f32_16x16x32_bf16 v[48:51], a[80:83], a[8:11], v[48:51]
    s_waitcnt lgkmcnt(6)
    ds_read_b64_tr_b16 a[28:29], v21 offset:24672
    ds_read_b64_tr_b16 a[30:31], v21 offset:25952
    v_mfma_f32_16x16x32_bf16 v[52:55], a[84:87], a[8:11], v[52:55]
    v_mfma_f32_16x16x32_bf16 v[56:59], a[80:83], a[12:15], v[56:59]
    s_waitcnt lgkmcnt(6)
    ds_read_b64_tr_b16 a[32:33], v20 offset:24704
    ds_read_b64_tr_b16 a[34:35], v20 offset:25984
    v_mfma_f32_16x16x32_bf16 v[60:63], a[84:87], a[12:15], v[60:63]
    v_mfma_f32_16x16x32_bf16 v[64:67], a[80:83], a[16:19], v[64:67]
    s_waitcnt lgkmcnt(6)
    ds_read_b64_tr_b16 a[36:37], v21 offset:24704
    ds_read_b64_tr_b16 a[38:39], v21 offset:25984
    v_mfma_f32_16x16x32_bf16 v[68:71], a[84:87], a[16:19], v[68:71]
    v_mfma_f32_16x16x32_bf16 v[72:75], a[80:83], a[20:23], v[72:75]
    s_waitcnt lgkmcnt(6)
    ds_read_b64_tr_b16 a[0:1], v20 offset:34816
    ds_read_b64_tr_b16 a[2:3], v20 offset:36096
    v_mfma_f32_16x16x32_bf16 v[76:79], a[84:87], a[20:23], v[76:79]
    v_mfma_f32_16x16x32_bf16 v[80:83], a[80:83], a[24:27], v[80:83]
    s_waitcnt lgkmcnt(6)
    ds_read_b64_tr_b16 a[4:5], v21 offset:34816
    ds_read_b64_tr_b16 a[6:7], v21 offset:36096
    v_mfma_f32_16x16x32_bf16 v[84:87], a[84:87], a[24:27], v[84:87]
    v_mfma_f32_16x16x32_bf16 v[88:91], a[80:83], a[28:31], v[88:91]
    s_waitcnt lgkmcnt(6)
    ds_read_b64_tr_b16 a[8:9], v20 offset:34848
    ds_read_b64_tr_b16 a[10:11], v20 offset:36128
    v_mfma_f32_16x16x32_bf16 v[92:95], a[84:87], a[28:31], v[92:95]
    v_mfma_f32_16x16x32_bf16 v[96:99], a[80:83], a[32:35], v[96:99]
    s_waitcnt lgkmcnt(6)
    ds_read_b64_tr_b16 a[12:13], v21 offset:34848
    ds_read_b64_tr_b16 a[14:15], v21 offset:36128
    v_mfma_f32_16x16x32_bf16 v[100:103], a[84:87], a[32:35], v[100:103]
    v_mfma_f32_16x16x32_bf16 v[104:107], a[80:83], a[36:39], v[104:107]
    s_waitcnt lgkmcnt(6)
    ds_read_b64_tr_b16 a[16:17], v20 offset:34880
    ds_read_b64_tr_b16 a[18:19], v20 offset:36160
    v_mfma_f32_16x16x32_bf16 v[108:111], a[84:87], a[36:39], v[108:111]
    v_mfma_f32_16x16x32_bf16 v[32:35], a[88:91], a[0:3], v[32:35]
    s_waitcnt lgkmcnt(6)
    ds_read_b64_tr_b16 a[20:21], v21 offset:34880
    ds_read_b64_tr_b16 a[22:23], v21 offset:36160
    v_mfma_f32_16x16x32_bf16 v[36:39], a[92:95], a[0:3], v[36:39]
    v_mfma_f32_16x16x32_bf16 v[40:43], a[88:91], a[4:7], v[40:43]
    s_waitcnt lgkmcnt(6)
    ds_read_b64_tr_b16 a[24:25], v20 offset:34912
    ds_read_b64_tr_b16 a[26:27], v20 offset:36192
    v_mfma_f32_16x16x32_bf16 v[44:47], a[92:95], a[4:7], v[44:47]
    v_mfma_f32_16x16x32_bf16 v[48:51], a[88:91], a[8:11], v[48:51]
    s_waitcnt lgkmcnt(6)
    ds_read_b64_tr_b16 a[28:29], v21 offset:34912
    ds_read_b64_tr_b16 a[30:31], v21 offset:36192
    v_mfma_f32_16x16x32_bf16 v[52:55], a[92:95], a[8:11], v[52:55]
    v_mfma_f32_16x16x32_bf16 v[56:59], a[88:91], a[12:15], v[56:59]
    s_waitcnt lgkmcnt(6)
    ds_read_b64_tr_b16 a[32:33], v20 offset:34944
    ds_read_b64_tr_b16 a[34:35], v20 offset:36224
    v_mfma_f32_16x16x32_bf16 v[60:63], a[92:95], a[12:15], v[60:63]
    v_mfma_f32_16x16x32_bf16 v[64:67], a[88:91], a[16:19], v[64:67]
    s_waitcnt lgkmcnt(6)
    ds_read_b64_tr_b16 a[36:37], v21 offset:34944
    ds_read_b64_tr_b16 a[38:39], v21 offset:36224
    v_mfma_f32_16x16x32_bf16 v[68:71], a[92:95], a[16:19], v[68:71]
    v_mfma_f32_16x16x32_bf16 v[72:75], a[88:91], a[20:23], v[72:75]
    s_waitcnt vmcnt(9)
    s_barrier
    s_waitcnt lgkmcnt(6)
    ds_read_b128 a[64:67], v16 offset:0
    ds_read_b128 a[68:71], v16 offset:2048
    v_mfma_f32_16x16x32_bf16 v[76:79], a[92:95], a[20:23], v[76:79]
    ds_read_b128 a[72:75], v17 offset:0
    v_mfma_f32_16x16x32_bf16 v[80:83], a[88:91], a[24:27], v[80:83]
    s_waitcnt lgkmcnt(7)
    ds_read_b128 a[76:79], v17 offset:2048
    ds_read_b64_tr_b16 a[0:1], v18 offset:0
    v_mfma_f32_16x16x32_bf16 v[84:87], a[92:95], a[24:27], v[84:87]
    ds_read_b64_tr_b16 a[2:3], v18 offset:1280
    s_load_dword s16, s[60:61], 0
    v_mfma_f32_16x16x32_bf16 v[88:91], a[88:91], a[28:31], v[88:91]
    s_waitcnt lgkmcnt(8)
    ds_read_b64_tr_b16 a[4:5], v19 offset:0
    ds_read_b64_tr_b16 a[6:7], v19 offset:1280
    v_mfma_f32_16x16x32_bf16 v[92:95], a[92:95], a[28:31], v[92:95]
    ds_read_b64_tr_b16 a[8:9], v18 offset:32
    v_mfma_f32_16x16x32_bf16 v[96:99], a[88:91], a[32:35], v[96:99]
    s_waitcnt lgkmcnt(9)
    ds_read_b64_tr_b16 a[10:11], v18 offset:1312
    ds_read_b64_tr_b16 a[12:13], v19 offset:32
    v_mfma_f32_16x16x32_bf16 v[100:103], a[92:95], a[32:35], v[100:103]
    ds_read_b64_tr_b16 a[14:15], v19 offset:1312
    s_add_u32 m0, s8, 8192
    s_add_u32 s64, s27, 36864
    buffer_load_dwordx4 v8, s[40:43], s64 offen offset:0  lds
    v_mfma_f32_16x16x32_bf16 v[104:107], a[88:91], a[36:39], v[104:107]
    s_waitcnt lgkmcnt(6)
    ds_read_b64_tr_b16 a[16:17], v18 offset:64
    ds_read_b64_tr_b16 a[18:19], v18 offset:1344
    v_mfma_f32_16x16x32_bf16 v[108:111], a[92:95], a[36:39], v[108:111]
    buffer_load_dwordx4 v9, s[40:43], s64 offen offset:1024  lds
    v_mfma_f32_16x16x32_bf16 v[32:35], a[64:67], a[0:3], v[32:35]
    s_waitcnt lgkmcnt(6)
    ds_read_b64_tr_b16 a[20:21], v18 offset:10240
    ds_read_b64_tr_b16 a[22:23], v18 offset:11520
    v_mfma_f32_16x16x32_bf16 v[36:39], a[68:71], a[0:3], v[36:39]
    v_mfma_f32_16x16x32_bf16 v[40:43], a[64:67], a[4:7], v[40:43]
    s_waitcnt lgkmcnt(6)
    ds_read_b64_tr_b16 a[24:25], v19 offset:10240
    ds_read_b64_tr_b16 a[26:27], v19 offset:11520
    v_mfma_f32_16x16x32_bf16 v[44:47], a[68:71], a[4:7], v[44:47]
    buffer_load_dwordx4 v10, s[40:43], s64 offen offset:2048  lds
    v_mfma_f32_16x16x32_bf16 v[48:51], a[64:67], a[8:11], v[48:51]
    s_waitcnt lgkmcnt(6)
    ds_read_b64_tr_b16 a[28:29], v18 offset:10272
    ds_read_b64_tr_b16 a[30:31], v18 offset:11552
    v_mfma_f32_16x16x32_bf16 v[52:55], a[68:71], a[8:11], v[52:55]
    v_mfma_f32_16x16x32_bf16 v[56:59], a[64:67], a[12:15], v[56:59]
    s_waitcnt lgkmcnt(6)
    ds_read_b64_tr_b16 a[32:33], v19 offset:10272
    ds_read_b64_tr_b16 a[34:35], v19 offset:11552
    v_mfma_f32_16x16x32_bf16 v[60:63], a[68:71], a[12:15], v[60:63]
    buffer_load_dwordx4 v11, s[40:43], s64 offen offset:3072  lds
    v_mfma_f32_16x16x32_bf16 v[64:67], a[64:67], a[16:19], v[64:67]
    s_waitcnt lgkmcnt(6)
    ds_read_b64_tr_b16 a[36:37], v18 offset:10304
    ds_read_b64_tr_b16 a[38:39], v18 offset:11584
    v_mfma_f32_16x16x32_bf16 v[68:71], a[68:71], a[16:19], v[68:71]
    s_add_u32 m0, s12, 49152
    s_add_u32 s65, s21, 737280
    buffer_load_dwordx4 v2, s[48:51], s65 offen offset:0  lds
    v_mfma_f32_16x16x32_bf16 v[32:35], a[72:75], a[20:23], v[32:35]
    s_waitcnt lgkmcnt(6)
    ds_read_b64_tr_b16 a[0:1], v19 offset:64
    ds_read_b64_tr_b16 a[2:3], v19 offset:1344
    v_mfma_f32_16x16x32_bf16 v[36:39], a[76:79], a[20:23], v[36:39]
    v_mfma_f32_16x16x32_bf16 v[40:43], a[72:75], a[24:27], v[40:43]
    s_waitcnt lgkmcnt(6)
    ds_read_b64_tr_b16 a[4:5], v18 offset:96
    ds_read_b64_tr_b16 a[6:7], v18 offset:1376
    v_mfma_f32_16x16x32_bf16 v[44:47], a[76:79], a[24:27], v[44:47]
    v_mfma_f32_16x16x32_bf16 v[48:51], a[72:75], a[28:31], v[48:51]
    s_waitcnt lgkmcnt(6)
    ds_read_b64_tr_b16 a[8:9], v19 offset:96
    ds_read_b64_tr_b16 a[10:11], v19 offset:1376
    v_mfma_f32_16x16x32_bf16 v[52:55], a[76:79], a[28:31], v[52:55]
    buffer_load_dwordx4 v3, s[48:51], s65 offen offset:1024  lds
    v_mfma_f32_16x16x32_bf16 v[56:59], a[72:75], a[32:35], v[56:59]
    s_waitcnt lgkmcnt(6)
    ds_read_b64_tr_b16 a[12:13], v18 offset:128
    ds_read_b64_tr_b16 a[14:15], v18 offset:1408
    v_mfma_f32_16x16x32_bf16 v[60:63], a[76:79], a[32:35], v[60:63]
    v_mfma_f32_16x16x32_bf16 v[64:67], a[72:75], a[36:39], v[64:67]
    s_waitcnt lgkmcnt(6)
    ds_read_b64_tr_b16 a[16:17], v19 offset:128
    ds_read_b64_tr_b16 a[18:19], v19 offset:1408
    v_mfma_f32_16x16x32_bf16 v[68:71], a[76:79], a[36:39], v[68:71]
    buffer_load_dwordx4 v4, s[48:51], s65 offen offset:2048  lds
    v_mfma_f32_16x16x32_bf16 v[72:75], a[64:67], a[0:3], v[72:75]
    s_waitcnt lgkmcnt(6)
    ds_read_b64_tr_b16 a[20:21], v19 offset:10304
    ds_read_b64_tr_b16 a[22:23], v19 offset:11584
    v_mfma_f32_16x16x32_bf16 v[76:79], a[68:71], a[0:3], v[76:79]
    v_mfma_f32_16x16x32_bf16 v[80:83], a[64:67], a[4:7], v[80:83]
    s_waitcnt lgkmcnt(6)
    ds_read_b64_tr_b16 a[24:25], v18 offset:10336
    ds_read_b64_tr_b16 a[26:27], v18 offset:11616
    v_mfma_f32_16x16x32_bf16 v[84:87], a[68:71], a[4:7], v[84:87]
    v_mfma_f32_16x16x32_bf16 v[88:91], a[64:67], a[8:11], v[88:91]
    s_waitcnt lgkmcnt(6)
    ds_read_b64_tr_b16 a[28:29], v19 offset:10336
    ds_read_b64_tr_b16 a[30:31], v19 offset:11616
    v_mfma_f32_16x16x32_bf16 v[92:95], a[68:71], a[8:11], v[92:95]
    v_cvt_pk_bf16_f32 v152, v32, v33
    v_cvt_pk_bf16_f32 v153, v34, v35
    s_add_u32 m0, s12, 52224
    s_nop 0
    buffer_load_dwordx4 v5, s[48:51], s65 offen offset:0  lds
    v_cvt_pk_bf16_f32 v154, v36, v37
    v_cvt_pk_bf16_f32 v155, v38, v39
    v_mfma_f32_16x16x32_bf16 v[96:99], a[64:67], a[12:15], v[96:99]
    s_waitcnt lgkmcnt(6)
    ds_read_b64_tr_b16 a[32:33], v18 offset:10368
    ds_read_b64_tr_b16 a[34:35], v18 offset:11648
    v_mfma_f32_16x16x32_bf16 v[100:103], a[68:71], a[12:15], v[100:103]
    v_cvt_pk_bf16_f32 v156, v40, v41
    v_cvt_pk_bf16_f32 v157, v42, v43
    v_mfma_f32_16x16x32_bf16 v[104:107], a[64:67], a[16:19], v[104:107]
    s_waitcnt lgkmcnt(6)
    ds_read_b64_tr_b16 a[36:37], v19 offset:10368
    ds_read_b64_tr_b16 a[38:39], v19 offset:11648
    v_mfma_f32_16x16x32_bf16 v[108:111], a[68:71], a[16:19], v[108:111]
    v_cvt_pk_bf16_f32 v158, v44, v45
    v_cvt_pk_bf16_f32 v159, v46, v47
    buffer_load_dwordx4 v6, s[48:51], s65 offen offset:1024  lds
    v_cvt_pk_bf16_f32 v160, v48, v49
    v_cvt_pk_bf16_f32 v161, v50, v51
    v_mfma_f32_16x16x32_bf16 v[72:75], a[72:75], a[20:23], v[72:75]
    s_waitcnt vmcnt(9)
    s_barrier
    s_waitcnt lgkmcnt(6)
    ds_read_b128 a[80:83], v16 offset:4096
    ds_read_b128 a[84:87], v16 offset:6144
    v_mfma_f32_16x16x32_bf16 v[76:79], a[76:79], a[20:23], v[76:79]
    ds_read_b128 a[88:91], v17 offset:4096
    v_mfma_f32_16x16x32_bf16 v[80:83], a[72:75], a[24:27], v[80:83]
    s_waitcnt lgkmcnt(7)
    ds_read_b128 a[92:95], v17 offset:6144
    ds_read_b64_tr_b16 a[0:1], v18 offset:24576
    v_mfma_f32_16x16x32_bf16 v[84:87], a[76:79], a[24:27], v[84:87]
    ds_read_b64_tr_b16 a[2:3], v18 offset:25856
    s_add_u32 m0, s8, 12288
    s_add_u32 s66, s28, 36864
    buffer_load_dwordx4 v8, s[40:43], s66 offen offset:0  lds
    v_cvt_pk_bf16_f32 v162, v52, v53
    v_cvt_pk_bf16_f32 v163, v54, v55
    v_mfma_f32_16x16x32_bf16 v[88:91], a[72:75], a[28:31], v[88:91]
    s_waitcnt lgkmcnt(8)
    ds_read_b64_tr_b16 a[4:5], v19 offset:24576
    ds_read_b64_tr_b16 a[6:7], v19 offset:25856
    v_mfma_f32_16x16x32_bf16 v[92:95], a[76:79], a[28:31], v[92:95]
    ds_read_b64_tr_b16 a[8:9], v18 offset:24608
    v_cvt_pk_bf16_f32 v164, v56, v57
    v_cvt_pk_bf16_f32 v165, v58, v59
    v_mfma_f32_16x16x32_bf16 v[96:99], a[72:75], a[32:35], v[96:99]
    s_waitcnt lgkmcnt(9)
    ds_read_b64_tr_b16 a[10:11], v18 offset:25888
    ds_read_b64_tr_b16 a[12:13], v19 offset:24608
    v_mfma_f32_16x16x32_bf16 v[100:103], a[76:79], a[32:35], v[100:103]
    ds_read_b64_tr_b16 a[14:15], v19 offset:25888
    buffer_load_dwordx4 v9, s[40:43], s66 offen offset:1024  lds
    v_cvt_pk_bf16_f32 v166, v60, v61
    v_cvt_pk_bf16_f32 v167, v62, v63
    v_mfma_f32_16x16x32_bf16 v[104:107], a[72:75], a[36:39], v[104:107]
    s_waitcnt lgkmcnt(6)
    ds_read_b64_tr_b16 a[16:17], v18 offset:24640
    ds_read_b64_tr_b16 a[18:19], v18 offset:25920
    v_mfma_f32_16x16x32_bf16 v[108:111], a[76:79], a[36:39], v[108:111]
    v_cvt_pk_bf16_f32 v168, v64, v65
    v_cvt_pk_bf16_f32 v169, v66, v67
    buffer_load_dwordx4 v10, s[40:43], s66 offen offset:2048  lds
    v_cvt_pk_bf16_f32 v170, v68, v69
    v_cvt_pk_bf16_f32 v171, v70, v71
    v_mfma_f32_16x16x32_bf16 v[32:35], a[80:83], a[0:3], 0
    s_waitcnt lgkmcnt(6)
    ds_read_b64_tr_b16 a[20:21], v18 offset:34816
    ds_read_b64_tr_b16 a[22:23], v18 offset:36096
    v_mfma_f32_16x16x32_bf16 v[36:39], a[84:87], a[0:3], 0
    v_mfma_f32_16x16x32_bf16 v[40:43], a[80:83], a[4:7], 0
    s_waitcnt lgkmcnt(6)
    ds_read_b64_tr_b16 a[24:25], v19 offset:34816
    ds_read_b64_tr_b16 a[26:27], v19 offset:36096
    v_mfma_f32_16x16x32_bf16 v[44:47], a[84:87], a[4:7], 0
    v_mfma_f32_16x16x32_bf16 v[48:51], a[80:83], a[8:11], 0
    s_waitcnt lgkmcnt(6)
    ds_read_b64_tr_b16 a[28:29], v18 offset:34848
    ds_read_b64_tr_b16 a[30:31], v18 offset:36128
    v_mfma_f32_16x16x32_bf16 v[52:55], a[84:87], a[8:11], 0
    v_cvt_pk_bf16_f32 v172, v72, v73
    v_cvt_pk_bf16_f32 v173, v74, v75
    buffer_load_dwordx4 v11, s[40:43], s66 offen offset:3072  lds
    v_cvt_pk_bf16_f32 v174, v76, v77
    v_cvt_pk_bf16_f32 v175, v78, v79
    v_mfma_f32_16x16x32_bf16 v[56:59], a[80:83], a[12:15], 0
    s_waitcnt lgkmcnt(6)
    ds_read_b64_tr_b16 a[32:33], v19 offset:34848
    ds_read_b64_tr_b16 a[34:35], v19 offset:36128
    v_mfma_f32_16x16x32_bf16 v[60:63], a[84:87], a[12:15], 0
    v_cvt_pk_bf16_f32 v176, v80, v81
    v_cvt_pk_bf16_f32 v177, v82, v83
    v_mfma_f32_16x16x32_bf16 v[64:67], a[80:83], a[16:19], 0
    s_waitcnt lgkmcnt(6)
    ds_read_b64_tr_b16 a[36:37], v18 offset:34880
    ds_read_b64_tr_b16 a[38:39], v18 offset:36160
    v_mfma_f32_16x16x32_bf16 v[68:71], a[84:87], a[16:19], 0
    v_cvt_pk_bf16_f32 v178, v84, v85
    v_cvt_pk_bf16_f32 v179, v86, v87
    s_add_u32 m0, s12, 73728
    s_add_u32 s67, s22, 737280
    buffer_load_dwordx4 v2, s[48:51], s67 offen offset:0  lds
    v_cvt_pk_bf16_f32 v180, v88, v89
    v_cvt_pk_bf16_f32 v181, v90, v91
    v_mfma_f32_16x16x32_bf16 v[32:35], a[88:91], a[20:23], v[32:35]
    s_waitcnt lgkmcnt(6)
    ds_read_b64_tr_b16 a[0:1], v19 offset:24640
    ds_read_b64_tr_b16 a[2:3], v19 offset:25920
    v_mfma_f32_16x16x32_bf16 v[36:39], a[92:95], a[20:23], v[36:39]
    v_mfma_f32_16x16x32_bf16 v[40:43], a[88:91], a[24:27], v[40:43]
    s_waitcnt lgkmcnt(6)
    ds_read_b64_tr_b16 a[4:5], v18 offset:24672
    ds_read_b64_tr_b16 a[6:7], v18 offset:25952
    v_mfma_f32_16x16x32_bf16 v[44:47], a[92:95], a[24:27], v[44:47]
    v_mfma_f32_16x16x32_bf16 v[48:51], a[88:91], a[28:31], v[48:51]
    s_waitcnt lgkmcnt(6)
    ds_read_b64_tr_b16 a[8:9], v19 offset:24672
    ds_read_b64_tr_b16 a[10:11], v19 offset:25952
    v_mfma_f32_16x16x32_bf16 v[52:55], a[92:95], a[28:31], v[52:55]
    v_cvt_pk_bf16_f32 v182, v92, v93
    v_cvt_pk_bf16_f32 v183, v94, v95
    buffer_load_dwordx4 v3, s[48:51], s67 offen offset:1024  lds
    v_cvt_pk_bf16_f32 v184, v96, v97
    v_cvt_pk_bf16_f32 v185, v98, v99
    v_mfma_f32_16x16x32_bf16 v[56:59], a[88:91], a[32:35], v[56:59]
    s_waitcnt lgkmcnt(6)
    ds_read_b64_tr_b16 a[12:13], v18 offset:24704
    ds_read_b64_tr_b16 a[14:15], v18 offset:25984
    v_mfma_f32_16x16x32_bf16 v[60:63], a[92:95], a[32:35], v[60:63]
    v_cvt_pk_bf16_f32 v186, v100, v101
    v_cvt_pk_bf16_f32 v187, v102, v103
    v_mfma_f32_16x16x32_bf16 v[64:67], a[88:91], a[36:39], v[64:67]
    s_waitcnt lgkmcnt(6)
    ds_read_b64_tr_b16 a[16:17], v19 offset:24704
    ds_read_b64_tr_b16 a[18:19], v19 offset:25984
    v_mfma_f32_16x16x32_bf16 v[68:71], a[92:95], a[36:39], v[68:71]
    v_cvt_pk_bf16_f32 v188, v104, v105
    v_cvt_pk_bf16_f32 v189, v106, v107
    buffer_load_dwordx4 v4, s[48:51], s67 offen offset:2048  lds
    v_cvt_pk_bf16_f32 v190, v108, v109
    v_cvt_pk_bf16_f32 v191, v110, v111
    v_mfma_f32_16x16x32_bf16 v[72:75], a[80:83], a[0:3], 0
    s_waitcnt lgkmcnt(6)
    ds_read_b64_tr_b16 a[20:21], v19 offset:34880
    ds_read_b64_tr_b16 a[22:23], v19 offset:36160
    v_mfma_f32_16x16x32_bf16 v[76:79], a[84:87], a[0:3], 0
    v_mfma_f32_16x16x32_bf16 v[80:83], a[80:83], a[4:7], 0
    s_waitcnt lgkmcnt(6)
    ds_read_b64_tr_b16 a[24:25], v18 offset:34912
    ds_read_b64_tr_b16 a[26:27], v18 offset:36192
    v_mfma_f32_16x16x32_bf16 v[84:87], a[84:87], a[4:7], 0
    v_mfma_f32_16x16x32_bf16 v[88:91], a[80:83], a[8:11], 0
    s_waitcnt lgkmcnt(6)
    ds_read_b64_tr_b16 a[28:29], v19 offset:34912
    ds_read_b64_tr_b16 a[30:31], v19 offset:36192
    v_mfma_f32_16x16x32_bf16 v[92:95], a[84:87], a[8:11], 0
    s_add_u32 m0, s12, 76800
    s_nop 0
    buffer_load_dwordx4 v5, s[48:51], s67 offen offset:0  lds
    v_mfma_f32_16x16x32_bf16 v[96:99], a[80:83], a[12:15], 0
    s_waitcnt lgkmcnt(6)
    ds_read_b64_tr_b16 a[32:33], v18 offset:34944
    ds_read_b64_tr_b16 a[34:35], v18 offset:36224
    v_mfma_f32_16x16x32_bf16 v[100:103], a[84:87], a[12:15], 0
    v_mfma_f32_16x16x32_bf16 v[104:107], a[80:83], a[16:19], 0
    s_waitcnt lgkmcnt(6)
    ds_read_b64_tr_b16 a[36:37], v19 offset:34944
    ds_read_b64_tr_b16 a[38:39], v19 offset:36224
    v_mfma_f32_16x16x32_bf16 v[108:111], a[84:87], a[16:19], 0
    buffer_load_dwordx4 v6, s[48:51], s67 offen offset:1024  lds
    v_mfma_f32_16x16x32_bf16 v[72:75], a[88:91], a[20:23], v[72:75]
    s_waitcnt vmcnt(9)
    s_barrier
    s_waitcnt lgkmcnt(6)
    ds_read_b128 a[64:67], v16 offset:8192
    ds_read_b128 a[68:71], v16 offset:10240
    v_mfma_f32_16x16x32_bf16 v[76:79], a[92:95], a[20:23], v[76:79]
    ds_read_b128 a[72:75], v17 offset:8192
    v_mfma_f32_16x16x32_bf16 v[80:83], a[88:91], a[24:27], v[80:83]
    s_waitcnt lgkmcnt(7)
    ds_read_b128 a[76:79], v17 offset:10240
    ds_read_b64_tr_b16 a[0:1], v20 offset:0
    v_mfma_f32_16x16x32_bf16 v[84:87], a[92:95], a[24:27], v[84:87]
    ds_read_b64_tr_b16 a[2:3], v20 offset:1280
    v_mfma_f32_16x16x32_bf16 v[88:91], a[88:91], a[28:31], v[88:91]
    s_waitcnt lgkmcnt(8)
    ds_read_b64_tr_b16 a[4:5], v21 offset:0
    ds_read_b64_tr_b16 a[6:7], v21 offset:1280
    v_mfma_f32_16x16x32_bf16 v[92:95], a[92:95], a[28:31], v[92:95]
    ds_read_b64_tr_b16 a[8:9], v20 offset:32
    v_mfma_f32_16x16x32_bf16 v[96:99], a[88:91], a[32:35], v[96:99]
    s_waitcnt lgkmcnt(9)
    ds_read_b64_tr_b16 a[10:11], v20 offset:1312
    ds_read_b64_tr_b16 a[12:13], v21 offset:32
    v_mfma_f32_16x16x32_bf16 v[100:103], a[92:95], a[32:35], v[100:103]
    ds_read_b64_tr_b16 a[14:15], v21 offset:1312
    v_mfma_f32_16x16x32_bf16 v[104:107], a[88:91], a[36:39], v[104:107]
    s_waitcnt lgkmcnt(6)
    ds_read_b64_tr_b16 a[16:17], v20 offset:64
    ds_read_b64_tr_b16 a[18:19], v20 offset:1344
    v_mfma_f32_16x16x32_bf16 v[108:111], a[92:95], a[36:39], v[108:111]
    v_mfma_f32_16x16x32_bf16 v[32:35], a[64:67], a[0:3], v[32:35]
    s_waitcnt lgkmcnt(6)
    ds_read_b64_tr_b16 a[20:21], v21 offset:64
    ds_read_b64_tr_b16 a[22:23], v21 offset:1344
    v_mfma_f32_16x16x32_bf16 v[36:39], a[68:71], a[0:3], v[36:39]
    v_mfma_f32_16x16x32_bf16 v[40:43], a[64:67], a[4:7], v[40:43]
    s_waitcnt lgkmcnt(6)
    ds_read_b64_tr_b16 a[24:25], v20 offset:96
    ds_read_b64_tr_b16 a[26:27], v20 offset:1376
    v_mfma_f32_16x16x32_bf16 v[44:47], a[68:71], a[4:7], v[44:47]
    v_mfma_f32_16x16x32_bf16 v[48:51], a[64:67], a[8:11], v[48:51]
    s_waitcnt lgkmcnt(6)
    ds_read_b64_tr_b16 a[28:29], v21 offset:96
    ds_read_b64_tr_b16 a[30:31], v21 offset:1376
    v_mfma_f32_16x16x32_bf16 v[52:55], a[68:71], a[8:11], v[52:55]
    v_mfma_f32_16x16x32_bf16 v[56:59], a[64:67], a[12:15], v[56:59]
    s_waitcnt lgkmcnt(6)
    ds_read_b64_tr_b16 a[32:33], v20 offset:128
    ds_read_b64_tr_b16 a[34:35], v20 offset:1408
    v_mfma_f32_16x16x32_bf16 v[60:63], a[68:71], a[12:15], v[60:63]
    v_mfma_f32_16x16x32_bf16 v[64:67], a[64:67], a[16:19], v[64:67]
    s_waitcnt lgkmcnt(6)
    ds_read_b64_tr_b16 a[36:37], v21 offset:128
    ds_read_b64_tr_b16 a[38:39], v21 offset:1408
    v_mfma_f32_16x16x32_bf16 v[68:71], a[68:71], a[16:19], v[68:71]
    v_mfma_f32_16x16x32_bf16 v[72:75], a[64:67], a[20:23], v[72:75]
    s_waitcnt lgkmcnt(6)
    ds_read_b64_tr_b16 a[0:1], v20 offset:10240
    ds_read_b64_tr_b16 a[2:3], v20 offset:11520
    v_mfma_f32_16x16x32_bf16 v[76:79], a[68:71], a[20:23], v[76:79]
    v_mfma_f32_16x16x32_bf16 v[80:83], a[64:67], a[24:27], v[80:83]
    s_waitcnt lgkmcnt(6)
    ds_read_b64_tr_b16 a[4:5], v21 offset:10240
    ds_read_b64_tr_b16 a[6:7], v21 offset:11520
    v_mfma_f32_16x16x32_bf16 v[84:87], a[68:71], a[24:27], v[84:87]
    v_mfma_f32_16x16x32_bf16 v[88:91], a[64:67], a[28:31], v[88:91]
    s_waitcnt lgkmcnt(6)
    ds_read_b64_tr_b16 a[8:9], v20 offset:10272
    ds_read_b64_tr_b16 a[10:11], v20 offset:11552
    v_mfma_f32_16x16x32_bf16 v[92:95], a[68:71], a[28:31], v[92:95]
    v_mfma_f32_16x16x32_bf16 v[96:99], a[64:67], a[32:35], v[96:99]
    s_waitcnt lgkmcnt(6)
    ds_read_b64_tr_b16 a[12:13], v21 offset:10272
    ds_read_b64_tr_b16 a[14:15], v21 offset:11552
    v_mfma_f32_16x16x32_bf16 v[100:103], a[68:71], a[32:35], v[100:103]
    v_mfma_f32_16x16x32_bf16 v[104:107], a[64:67], a[36:39], v[104:107]
    s_waitcnt lgkmcnt(6)
    ds_read_b64_tr_b16 a[16:17], v20 offset:10304
    ds_read_b64_tr_b16 a[18:19], v20 offset:11584
    v_mfma_f32_16x16x32_bf16 v[108:111], a[68:71], a[36:39], v[108:111]
    v_mfma_f32_16x16x32_bf16 v[32:35], a[72:75], a[0:3], v[32:35]
    s_waitcnt lgkmcnt(6)
    ds_read_b64_tr_b16 a[20:21], v21 offset:10304
    ds_read_b64_tr_b16 a[22:23], v21 offset:11584
    v_mfma_f32_16x16x32_bf16 v[36:39], a[76:79], a[0:3], v[36:39]
    v_mfma_f32_16x16x32_bf16 v[40:43], a[72:75], a[4:7], v[40:43]
    s_waitcnt lgkmcnt(6)
    ds_read_b64_tr_b16 a[24:25], v20 offset:10336
    ds_read_b64_tr_b16 a[26:27], v20 offset:11616
    v_mfma_f32_16x16x32_bf16 v[44:47], a[76:79], a[4:7], v[44:47]
    v_mfma_f32_16x16x32_bf16 v[48:51], a[72:75], a[8:11], v[48:51]
    s_waitcnt lgkmcnt(6)
    ds_read_b64_tr_b16 a[28:29], v21 offset:10336
    ds_read_b64_tr_b16 a[30:31], v21 offset:11616
    v_mfma_f32_16x16x32_bf16 v[52:55], a[76:79], a[8:11], v[52:55]
    v_mfma_f32_16x16x32_bf16 v[56:59], a[72:75], a[12:15], v[56:59]
    s_waitcnt lgkmcnt(6)
    ds_read_b64_tr_b16 a[32:33], v20 offset:10368
    ds_read_b64_tr_b16 a[34:35], v20 offset:11648
    v_mfma_f32_16x16x32_bf16 v[60:63], a[76:79], a[12:15], v[60:63]
    v_mfma_f32_16x16x32_bf16 v[64:67], a[72:75], a[16:19], v[64:67]
    s_waitcnt lgkmcnt(6)
    ds_read_b64_tr_b16 a[36:37], v21 offset:10368
    ds_read_b64_tr_b16 a[38:39], v21 offset:11648
    v_mfma_f32_16x16x32_bf16 v[68:71], a[76:79], a[16:19], v[68:71]
    s_waitcnt lgkmcnt(0)
    s_cmp_lg_u32 s16, 0
    s_cbranch_scc1 L_ngB1
    s_mov_b32 s17, 20000
L_ngB0:
    buffer_load_dword v28, v0, s[60:63], 0 offen sc1
    s_waitcnt vmcnt(0)
    v_readfirstlane_b32 s16, v28
    s_nop 0
    s_cmp_lg_u32 s16, 0
    s_cbranch_scc1 L_ngB1
    s_sub_u32 s17, s17, 1
    s_cmp_lg_u32 s17, 0
    s_cbranch_scc1 L_ngB0
L_ngB1:
    s_mov_b32 s17, 64
    s_mov_b32 s29, 0
    v_mov_b32 v243, s16
    v_mov_b32 v247, s16
    s_and_b32 s18, s16, 0xffff0000
    v_mfma_f32_16x16x32_bf16 v[72:75], a[72:75], a[20:23], v[72:75]
    s_waitcnt vmcnt(0)
    s_barrier
    s_waitcnt lgkmcnt(6)
    ds_read_b128 a[80:83], v16 offset:12288
    ds_read_b128 a[84:87], v16 offset:14336
    v_mfma_f32_16x16x32_bf16 v[76:79], a[76:79], a[20:23], v[76:79]
    ds_read_b128 a[88:91], v17 offset:12288
    v_mfma_f32_16x16x32_bf16 v[80:83], a[72:75], a[24:27], v[80:83]
    s_waitcnt lgkmcnt(7)
    ds_read_b128 a[92:95], v17 offset:14336
    ds_read_b64_tr_b16 a[0:1], v20 offset:24576
    v_mfma_f32_16x16x32_bf16 v[84:87], a[76:79], a[24:27], v[84:87]
    ds_read_b64_tr_b16 a[2:3], v20 offset:25856
    v_mfma_f32_16x16x32_bf16 v[88:91], a[72:75], a[28:31], v[88:91]
    s_waitcnt lgkmcnt(8)
    ds_read_b64_tr_b16 a[4:5], v21 offset:24576
    ds_read_b64_tr_b16 a[6:7], v21 offset:25856
    v_mfma_f32_16x16x32_bf16 v[92:95], a[76:79], a[28:31], v[92:95]
    ds_read_b64_tr_b16 a[8:9], v20 offset:24608
    v_mfma_f32_16x16x32_bf16 v[96:99], a[72:75], a[32:35], v[96:99]
    s_waitcnt lgkmcnt(9)
    ds_read_b64_tr_b16 a[10:11], v20 offset:25888
    ds_read_b64_tr_b16 a[12:13], v21 offset:24608
    v_mfma_f32_16x16x32_bf16 v[100:103], a[76:79], a[32:35], v[100:103]
    ds_read_b64_tr_b16 a[14:15], v21 offset:25888
    v_mfma_f32_16x16x32_bf16 v[104:107], a[72:75], a[36:39], v[104:107]
    s_waitcnt lgkmcnt(6)
    ds_read_b64_tr_b16 a[16:17], v20 offset:24640
    ds_read_b64_tr_b16 a[18:19], v20 offset:25920
    v_mfma_f32_16x16x32_bf16 v[108:111], a[76:79], a[36:39], v[108:111]
    v_mfma_f32_16x16x32_bf16 v[32:35], a[80:83], a[0:3], v[32:35]
    s_waitcnt lgkmcnt(6)
    ds_read_b64_tr_b16 a[20:21], v20 offset:34816
    ds_read_b64_tr_b16 a[22:23], v20 offset:36096
    v_mfma_f32_16x16x32_bf16 v[36:39], a[84:87], a[0:3], v[36:39]
    v_mfma_f32_16x16x32_bf16 v[40:43], a[80:83], a[4:7], v[40:43]
    s_waitcnt lgkmcnt(6)
    ds_read_b64_tr_b16 a[24:25], v21 offset:34816
    ds_read_b64_tr_b16 a[26:27], v21 offset:36096
    v_mfma_f32_16x16x32_bf16 v[44:47], a[84:87], a[4:7], v[44:47]
    v_mfma_f32_16x16x32_bf16 v[48:51], a[80:83], a[8:11], v[48:51]
    s_waitcnt lgkmcnt(6)
    ds_read_b64_tr_b16 a[28:29], v20 offset:34848
    ds_read_b64_tr_b16 a[30:31], v20 offset:36128
    v_mfma_f32_16x16x32_bf16 v[52:55], a[84:87], a[8:11], v[52:55]
    v_mfma_f32_16x16x32_bf16 v[56:59], a[80:83], a[12:15], v[56:59]
    s_waitcnt lgkmcnt(6)
    ds_read_b64_tr_b16 a[32:33], v21 offset:34848
    ds_read_b64_tr_b16 a[34:35], v21 offset:36128
    v_mfma_f32_16x16x32_bf16 v[60:63], a[84:87], a[12:15], v[60:63]
    v_mfma_f32_16x16x32_bf16 v[64:67], a[80:83], a[16:19], v[64:67]
    s_waitcnt lgkmcnt(6)
    ds_read_b64_tr_b16 a[36:37], v20 offset:34880
    ds_read_b64_tr_b16 a[38:39], v20 offset:36160
    v_mfma_f32_16x16x32_bf16 v[68:71], a[84:87], a[16:19], v[68:71]
    buffer_load_dword v29, v13, s[56:59], s47 offen offset:3068 sc1
    v_mfma_f32_16x16x32_bf16 v[32:35], a[88:91], a[20:23], v[32:35]
    s_waitcnt lgkmcnt(6)
    ds_read_b64_tr_b16 a[0:1], v21 offset:24640
    ds_read_b64_tr_b16 a[2:3], v21 offset:25920
    v_mfma_f32_16x16x32_bf16 v[36:39], a[92:95], a[20:23], v[36:39]
    v_mfma_f32_16x16x32_bf16 v[40:43], a[88:91], a[24:27], v[40:43]
    s_waitcnt lgkmcnt(6)
    ds_read_b64_tr_b16 a[4:5], v20 offset:24672
    ds_read_b64_tr_b16 a[6:7], v20 offset:25952
    v_mfma_f32_16x16x32_bf16 v[44:47], a[92:95], a[24:27], v[44:47]
    v_mfma_f32_16x16x32_bf16 v[48:51], a[88:91], a[28:31], v[48:51]
    s_waitcnt lgkmcnt(6)
    ds_read_b64_tr_b16 a[8:9], v21 offset:24672
    ds_read_b64_tr_b16 a[10:11], v21 offset:25952
    v_mfma_f32_16x16x32_bf16 v[52:55], a[92:95], a[28:31], v[52:55]
    v_mfma_f32_16x16x32_bf16 v[56:59], a[88:91], a[32:35], v[56:59]
    s_waitcnt lgkmcnt(6)
    ds_read_b64_tr_b16 a[12:13], v20 offset:24704
    ds_read_b64_tr_b16 a[14:15], v20 offset:25984
    v_mfma_f32_16x16x32_bf16 v[60:63], a[92:95], a[32:35], v[60:63]
    v_mfma_f32_16x16x32_bf16 v[64:67], a[88:91], a[36:39], v[64:67]
    s_waitcnt lgkmcnt(6)
    ds_read_b64_tr_b16 a[16:17], v21 offset:24704
    ds_read_b64_tr_b16 a[18:19], v21 offset:25984
    v_mfma_f32_16x16x32_bf16 v[68:71], a[92:95], a[36:39], v[68:71]
    v_mfma_f32_16x16x32_bf16 v[72:75], a[80:83], a[0:3], v[72:75]
    s_waitcnt lgkmcnt(6)
    ds_read_b64_tr_b16 a[20:21], v21 offset:34880
    ds_read_b64_tr_b16 a[22:23], v21 offset:36160
    v_mfma_f32_16x16x32_bf16 v[76:79], a[84:87], a[0:3], v[76:79]
    v_mfma_f32_16x16x32_bf16 v[80:83], a[80:83], a[4:7], v[80:83]
    s_waitcnt lgkmcnt(6)
    ds_read_b64_tr_b16 a[24:25], v20 offset:34912
    ds_read_b64_tr_b16 a[26:27], v20 offset:36192
    v_mfma_f32_16x16x32_bf16 v[84:87], a[84:87], a[4:7], v[84:87]
    s_waitcnt vmcnt(0)
    v_cmp_eq_u32 vcc, s16, v29
    s_sub_u32 s17, s17, 1
    s_cmp_eq_u32 s17, 0
    s_cselect_b32 s14, -1, vcc_lo
    s_andn2_b32 s14, s14, s29
    s_and_b32 s14, s14, 15
    s_cbranch_scc0 L_pee
    s_or_b32 s29, s29, s14
    s_bitcmp1_b32 s14, 0
    s_cbranch_scc0 L_pe0
    buffer_load_dwordx4 v[192:195], v24, s[56:59], s32 offen offset:0 sc1
    buffer_load_dwordx4 v[196:199], v24, s[56:59], s32 offen offset:1024 sc1
    buffer_load_dwordx4 v[224:227], v24, s[56:59], s32 offen offset:2048 sc1
L_pe0:
    s_bitcmp1_b32 s14, 1
    s_cbranch_scc0 L_pe1
    buffer_load_dwordx4 v[200:203], v24, s[56:59], s33 offen offset:0 sc1
    buffer_load_dwordx4 v[204:207], v24, s[56:59], s33 offen offset:1024 sc1
    buffer_load_dwordx4 v[228:231], v24, s[56:59], s33 offen offset:2048 sc1
L_pe1:
    s_bitcmp1_b32 s14, 2
    s_cbranch_scc0 L_pe2
    buffer_load_dwordx4 v[208:211], v24, s[56:59], s34 offen offset:0 sc1
    buffer_load_dwordx4 v[212:215], v24, s[56:59], s34 offen offset:1024 sc1
    buffer_load_dwordx4 v[232:235], v24, s[56:59], s34 offen offset:2048 sc1
L_pe2:
    s_bitcmp1_b32 s14, 3
    s_cbranch_scc0 L_pe3
    buffer_load_dwordx4 v[216:219], v24, s[56:59], s35 offen offset:0 sc1
    buffer_load_dwordx4 v[220:223], v24, s[56:59], s35 offen offset:1024 sc1
    buffer_load_dwordx4 v[236:239], v24, s[56:59], s35 offen offset:2048 sc1
L_pe3:
L_pee:
    buffer_load_dword v29, v13, s[56:59], s47 offen offset:3068 sc1
    v_mfma_f32_16x16x32_bf16 v[88:91], a[80:83], a[8:11], v[88:91]
    s_waitcnt lgkmcnt(6)
    ds_read_b64_tr_b16 a[28:29], v21 offset:34912
    ds_read_b64_tr_b16 a[30:31], v21 offset:36192
    v_mfma_f32_16x16x32_bf16 v[92:95], a[84:87], a[8:11], v[92:95]
    v_cvt_pk_bf16_f32 v32, v32, v33
    v_cvt_pk_bf16_f32 v33, v34, v35
    v_cvt_pk_bf16_f32 v34, v36, v37
    v_cvt_pk_bf16_f32 v35, v38, v39
    v_mfma_f32_16x16x32_bf16 v[96:99], a[80:83], a[12:15], v[96:99]
    s_waitcnt lgkmcnt(6)
    ds_read_b64_tr_b16 a[32:33], v20 offset:34944
    ds_read_b64_tr_b16 a[34:35], v20 offset:36224
    v_mfma_f32_16x16x32_bf16 v[100:103], a[84:87], a[12:15], v[100:103]
    v_cvt_pk_bf16_f32 v36, v40, v41
    v_cvt_pk_bf16_f32 v37, v42, v43
    v_mfma_f32_16x16x32_bf16 v[104:107], a[80:83], a[16:19], v[104:107]
    s_waitcnt lgkmcnt(6)
    ds_read_b64_tr_b16 a[36:37], v21 offset:34944
    ds_read_b64_tr_b16 a[38:39], v21 offset:36224
    v_mfma_f32_16x16x32_bf16 v[108:111], a[84:87], a[16:19], v[108:111]
    v_cvt_pk_bf16_f32 v38, v44, v45
    v_cvt_pk_bf16_f32 v39, v46, v47
    v_cvt_pk_bf16_f32 v40, v48, v49
    v_cvt_pk_bf16_f32 v41, v50, v51
    v_mfma_f32_16x16x32_bf16 v[72:75], a[88:91], a[20:23], v[72:75]
    s_waitcnt lgkmcnt(6)
    v_mfma_f32_16x16x32_bf16 v[76:79], a[92:95], a[20:23], v[76:79]
    v_cvt_pk_bf16_f32 v42, v52, v53
    v_cvt_pk_bf16_f32 v43, v54, v55
    v_mfma_f32_16x16x32_bf16 v[80:83], a[88:91], a[24:27], v[80:83]
    s_waitcnt lgkmcnt(4)
    v_mfma_f32_16x16x32_bf16 v[84:87], a[92:95], a[24:27], v[84:87]
    v_cvt_pk_bf16_f32 v44, v56, v57
    v_cvt_pk_bf16_f32 v45, v58, v59
    v_mfma_f32_16x16x32_bf16 v[88:91], a[88:91], a[28:31], v[88:91]
    s_waitcnt lgkmcnt(2)
    v_mfma_f32_16x16x32_bf16 v[92:95], a[92:95], a[28:31], v[92:95]
    v_cvt_pk_bf16_f32 v46, v60, v61
    v_cvt_pk_bf16_f32 v47, v62, v63
    v_mfma_f32_16x16x32_bf16 v[96:99], a[88:91], a[32:35], v[96:99]
    s_waitcnt lgkmcnt(0)
    v_mfma_f32_16x16x32_bf16 v[100:103], a[92:95], a[32:35], v[100:103]
    v_cvt_pk_bf16_f32 v48, v64, v65
    v_cvt_pk_bf16_f32 v49, v66, v67
    v_mfma_f32_16x16x32_bf16 v[104:107], a[88:91], a[36:39], v[104:107]
    v_mfma_f32_16x16x32_bf16 v[108:111], a[92:95], a[36:39], v[108:111]
    v_cvt_pk_bf16_f32 v50, v68, v69
    v_cvt_pk_bf16_f32 v51, v70, v71
    s_waitcnt vmcnt(0)
    v_cmp_eq_u32 vcc, s16, v29
    s_sub_u32 s17, s17, 1
    s_cmp_eq_u32 s17, 0
    s_cselect_b32 s14, -1, vcc_lo
    s_and_b32 s13, s14, 15
    s_bcnt1_i32_b32 s13, s13
    s_cmp_ge_u32 s13, 2
    s_cselect_b32 s14, -1, s14
    s_andn2_b32 s14, s14, s29
    s_and_b32 s14, s14, 15
    s_cbranch_scc0 L_pfe
    s_or_b32 s29, s29, s14
    s_bitcmp1_b32 s14, 0
    s_cbranch_scc0 L_pf0
    buffer_load_dwordx4 v[192:195], v24, s[56:59], s32 offen offset:0 sc1
    buffer_load_dwordx4 v[196:199], v24, s[56:59], s32 offen offset:1024 sc1
    buffer_load_dwordx4 v[224:227], v24, s[56:59], s32 offen offset:2048 sc1
L_pf0:
    s_bitcmp1_b32 s14, 1
    s_cbranch_scc0 L_pf1
    buffer_load_dwordx4 v[200:203], v24, s[56:59], s33 offen offset:0 sc1
    buffer_load_dwordx4 v[204:207], v24, s[56:59], s33 offen offset:1024 sc1
    buffer_load_dwordx4 v[228:231], v24, s[56:59], s33 offen offset:2048 sc1
L_pf1:
    s_bitcmp1_b32 s14, 2
    s_cbranch_scc0 L_pf2
    buffer_load_dwordx4 v[208:211], v24, s[56:59], s34 offen offset:0 sc1
    buffer_load_dwordx4 v[212:215], v24, s[56:59], s34 offen offset:1024 sc1
    buffer_load_dwordx4 v[232:235], v24, s[56:59], s34 offen offset:2048 sc1
L_pf2:
    s_bitcmp1_b32 s14, 3
    s_cbranch_scc0 L_pf3
    buffer_load_dwordx4 v[216:219], v24, s[56:59], s35 offen offset:0 sc1
    buffer_load_dwordx4 v[220:223], v24, s[56:59], s35 offen offset:1024 sc1
    buffer_load_dwordx4 v[236:239], v24, s[56:59], s35 offen offset:2048 sc1
L_pf3:
L_pfe:
    buffer_load_dword v29, v13, s[56:59], s47 offen offset:3068 sc1
    v_cvt_pk_bf16_f32 v52, v72, v73
    v_cvt_pk_bf16_f32 v53, v74, v75
    v_cvt_pk_bf16_f32 v54, v76, v77
    v_cvt_pk_bf16_f32 v55, v78, v79
    v_cvt_pk_bf16_f32 v56, v80, v81
    v_cvt_pk_bf16_f32 v57, v82, v83
    v_cvt_pk_bf16_f32 v58, v84, v85
    v_cvt_pk_bf16_f32 v59, v86, v87
    v_cvt_pk_bf16_f32 v60, v88, v89
    v_cvt_pk_bf16_f32 v61, v90, v91
    v_cvt_pk_bf16_f32 v62, v92, v93
    v_cvt_pk_bf16_f32 v63, v94, v95
    v_cvt_pk_bf16_f32 v64, v96, v97
    v_cvt_pk_bf16_f32 v65, v98, v99
    v_cvt_pk_bf16_f32 v66, v100, v101
    v_cvt_pk_bf16_f32 v67, v102, v103
    v_cvt_pk_bf16_f32 v68, v104, v105
    v_cvt_pk_bf16_f32 v69, v106, v107
    v_cvt_pk_bf16_f32 v70, v108, v109
    v_cvt_pk_bf16_f32 v71, v110, v111
    s_cmp_eq_u32 s29, 15
    s_cbranch_scc1 L_pc2
    s_branch L_pc1
L_pc0:
    buffer_load_dword v29, v13, s[56:59], s47 offen offset:3068 sc1
L_pc1:
    s_waitcnt vmcnt(0)
    v_cmp_eq_u32 vcc, s16, v29
    s_sub_u32 s17, s17, 1
    s_cmp_eq_u32 s17, 0
    s_cselect_b32 s14, -1, vcc_lo
    s_and_b32 s13, s14, 15
    s_bcnt1_i32_b32 s13, s13
    s_cmp_ge_u32 s13, 2
    s_cselect_b32 s14, -1, s14
    s_andn2_b32 s14, s14, s29
    s_and_b32 s14, s14, 15
    s_cbranch_scc0 L_pge
    s_or_b32 s29, s29, s14
    s_bitcmp1_b32 s14, 0
    s_cbranch_scc0 L_pg0
    buffer_load_dwordx4 v[192:195], v24, s[56:59], s32 offen offset:0 sc1
    buffer_load_dwordx4 v[196:199], v24, s[56:59], s32 offen offset:1024 sc1
    buffer_load_dwordx4 v[224:227], v24, s[56:59], s32 offen offset:2048 sc1
L_pg0:
    s_bitcmp1_b32 s14, 1
    s_cbranch_scc0 L_pg1
    buffer_load_dwordx4 v[200:203], v24, s[56:59], s33 offen offset:0 sc1
    buffer_load_dwordx4 v[204:207], v24, s[56:59], s33 offen offset:1024 sc1
    buffer_load_dwordx4 v[228:231], v24, s[56:59], s33 offen offset:2048 sc1
L_pg1:
    s_bitcmp1_b32 s14, 2
    s_cbranch_scc0 L_pg2
    buffer_load_dwordx4 v[208:211], v24, s[56:59], s34 offen offset:0 sc1
    buffer_load_dwordx4 v[212:215], v24, s[56:59], s34 offen offset:1024 sc1
    buffer_load_dwordx4 v[232:235], v24, s[56:59], s34 offen offset:2048 sc1
L_pg2:
    s_bitcmp1_b32 s14, 3
    s_cbranch_scc0 L_pg3
    buffer_load_dwordx4 v[216:219], v24, s[56:59], s35 offen offset:0 sc1
    buffer_load_dwordx4 v[220:223], v24, s[56:59], s35 offen offset:1024 sc1
    buffer_load_dwordx4 v[236:239], v24, s[56:59], s35 offen offset:2048 sc1
L_pg3:
L_pge:
    s_cmp_lg_u32 s29, 15
    s_cbranch_scc1 L_pc0
L_pc2:
    s_waitcnt vmcnt(0)
    v_min3_u32 v25, v195, v199, v227
    v_max3_u32 v26, v195, v199, v227
    v_min3_u32 v25, v25, v203, v207
    v_max3_u32 v26, v26, v203, v207
    v_min3_u32 v25, v25, v231, v211
    v_max3_u32 v26, v26, v231, v211
    v_min3_u32 v25, v25, v215, v235
    v_max3_u32 v26, v26, v215, v235
    v_min3_u32 v25, v25, v219, v223
    v_max3_u32 v26, v26, v219, v223
    v_min3_u32 v25, v25, v239, s16
    v_max3_u32 v26, v26, v239, s16
    v_cmp_ne_u32 vcc, v25, v26
    s_mov_b32 s17, 20031
    s_mov_b32 s29, 15
    s_cbranch_vccz L_pl1
L_pl0:
    s_and_b32 s14, s17, 31
    s_cmp_lt_u32 s14, 2
    s_cselect_b32 s14, 12582912, 0
    s_xor_b32 s32, s32, s14
    s_xor_b32 s33, s33, s14
    s_xor_b32 s34, s34, s14
    s_xor_b32 s35, s35, s14
    s_bitcmp1_b32 s29, 0
    s_cbranch_scc0 L_ph0
    v_min3_u32 v25, v195, v199, v227
    v_max3_u32 v26, v195, v199, v227
    v_min_u32 v25, s16, v25
    v_max_u32 v26, s16, v26
    v_cmp_ne_u32 vcc, v25, v26
    s_bitset0_b32 s29, 0
    s_nop 0
    s_cbranch_vccz L_ph0
    s_bitset1_b32 s29, 0
    buffer_load_dwordx4 v[192:195], v24, s[56:59], s32 offen offset:0 sc1
    buffer_load_dwordx4 v[196:199], v24, s[56:59], s32 offen offset:1024 sc1
    buffer_load_dwordx4 v[224:227], v24, s[56:59], s32 offen offset:2048 sc1
L_ph0:
    s_bitcmp1_b32 s29, 1
    s_cbranch_scc0 L_ph1
    v_min3_u32 v25, v203, v207, v231
    v_max3_u32 v26, v203, v207, v231
    v_min_u32 v25, s16, v25
    v_max_u32 v26, s16, v26
    v_cmp_ne_u32 vcc, v25, v26
    s_bitset0_b32 s29, 1
    s_nop 0
    s_cbranch_vccz L_ph1
    s_bitset1_b32 s29, 1
    buffer_load_dwordx4 v[200:203], v24, s[56:59], s33 offen offset:0 sc1
    buffer_load_dwordx4 v[204:207], v24, s[56:59], s33 offen offset:1024 sc1
    buffer_load_dwordx4 v[228:231], v24, s[56:59], s33 offen offset:2048 sc1
L_ph1:
    s_bitcmp1_b32 s29, 2
    s_cbranch_scc0 L_ph2
    v_min3_u32 v25, v211, v215, v235
    v_max3_u32 v26, v211, v215, v235
    v_min_u32 v25, s16, v25
    v_max_u32 v26, s16, v26
    v_cmp_ne_u32 vcc, v25, v26
    s_bitset0_b32 s29, 2
    s_nop 0
    s_cbranch_vccz L_ph2
    s_bitset1_b32 s29, 2
    buffer_load_dwordx4 v[208:211], v24, s[56:59], s34 offen offset:0 sc1
    buffer_load_dwordx4 v[212:215], v24, s[56:59], s34 offen offset:1024 sc1
    buffer_load_dwordx4 v[232:235], v24, s[56:59], s34 offen offset:2048 sc1
L_ph2:
    s_bitcmp1_b32 s29, 3
    s_cbranch_scc0 L_ph3
    v_min3_u32 v25, v219, v223, v239
    v_max3_u32 v26, v219, v223, v239
    v_min_u32 v25, s16, v25
    v_max_u32 v26, s16, v26
    v_cmp_ne_u32 vcc, v25, v26
    s_bitset0_b32 s29, 3
    s_nop 0
    s_cbranch_vccz L_ph3
    s_bitset1_b32 s29, 3
    buffer_load_dwordx4 v[216:219], v24, s[56:59], s35 offen offset:0 sc1
    buffer_load_dwordx4 v[220:223], v24, s[56:59], s35 offen offset:1024 sc1
    buffer_load_dwordx4 v[236:239], v24, s[56:59], s35 offen offset:2048 sc1
L_ph3:
    s_cmp_eq_u32 s29, 0
    s_cbranch_scc1 L_pl1
    s_waitcnt vmcnt(0)
    s_sub_u32 s17, s17, 1
    s_cmp_lg_u32 s17, 0
    s_cbranch_scc1 L_pl0
L_pl1:
    v_mov_b32 v195, v224
    v_mov_b32 v199, v225
    v_mov_b32 v203, v228
    v_mov_b32 v207, v229
    v_mov_b32 v211, v232
    v_mov_b32 v215, v233
    v_mov_b32 v219, v236
    v_mov_b32 v223, v237
    v_mfma_f32_16x16x32_bf16 v[72:75], a[96:99], v[192:195], 0
    v_mfma_f32_16x16x32_bf16 v[76:79], a[96:99], v[196:199], 0
    v_mfma_f32_16x16x32_bf16 v[72:75], v[112:115], v[200:203], v[72:75]
    v_mfma_f32_16x16x32_bf16 v[76:79], v[112:115], v[204:207], v[76:79]
    v_mfma_f32_16x16x32_bf16 v[72:75], v[152:155], v[208:211], v[72:75]
    v_mfma_f32_16x16x32_bf16 v[76:79], v[152:155], v[212:215], v[76:79]
    v_mfma_f32_16x16x32_bf16 v[72:75], v[32:35], v[216:219], v[72:75]
    v_mfma_f32_16x16x32_bf16 v[76:79], v[32:35], v[220:223], v[76:79]
    v_mfma_f32_16x16x32_bf16 v[80:83], a[100:103], v[192:195], 0
    s_nop 1
    v_mfma_f32_16x16x32_bf16 v[84:87], a[100:103], v[196:199], 0
    s_nop 0
    v_mfma_f32_16x16x32_bf16 v[80:83], v[116:119], v[200:203], v[80:83]
    v_mfma_f32_16x16x32_bf16 v[84:87], v[116:119], v[204:207], v[84:87]
    v_cvt_pk_bf16_f32 v248, v72, v73
    v_cvt_pk_bf16_f32 v249, v74, v75
    v_mfma_f32_16x16x32_bf16 v[80:83], v[156:159], v[208:211], v[80:83]
    v_cvt_pk_bf16_f32 v250, v76, v77
    v_cvt_pk_bf16_f32 v251, v78, s18
    v_mfma_f32_16x16x32_bf16 v[84:87], v[156:159], v[212:215], v[84:87]
    v_cvt_pk_bf16_f32 v255, v79, s18
    v_mfma_f32_16x16x32_bf16 v[80:83], v[36:39], v[216:219], v[80:83]
    buffer_store_dwordx4 v[248:251], v12, s[56:59], s44 offen offset:0 sc1
    v_mfma_f32_16x16x32_bf16 v[84:87], v[36:39], v[220:223], v[84:87]
    v_mfma_f32_16x16x32_bf16 v[88:91], a[104:107], v[192:195], 0
    s_nop 1
    v_mfma_f32_16x16x32_bf16 v[92:95], a[104:107], v[196:199], 0
    s_nop 0
    v_mfma_f32_16x16x32_bf16 v[88:91], v[120:123], v[200:203], v[88:91]
    v_mfma_f32_16x16x32_bf16 v[92:95], v[120:123], v[204:207], v[92:95]
    v_cvt_pk_bf16_f32 v252, v80, v81
    v_cvt_pk_bf16_f32 v253, v82, v83
    v_mfma_f32_16x16x32_bf16 v[88:91], v[160:163], v[208:211], v[88:91]
    v_cvt_pk_bf16_f32 v254, v84, v85
    v_cvt_pk_bf16_f32 v104, v86, v87
    v_mfma_f32_16x16x32_bf16 v[92:95], v[160:163], v[212:215], v[92:95]
    buffer_store_dwordx4 v[252:255], v12, s[56:59], s44 offen offset:1024 sc1
    v_mfma_f32_16x16x32_bf16 v[88:91], v[40:43], v[216:219], v[88:91]
    v_mfma_f32_16x16x32_bf16 v[92:95], v[40:43], v[220:223], v[92:95]
    v_mfma_f32_16x16x32_bf16 v[96:99], a[108:111], v[192:195], 0
    s_nop 1
    v_mfma_f32_16x16x32_bf16 v[100:103], a[108:111], v[196:199], 0
    s_nop 0
    v_mfma_f32_16x16x32_bf16 v[96:99], v[124:127], v[200:203], v[96:99]
    v_mfma_f32_16x16x32_bf16 v[100:103], v[124:127], v[204:207], v[100:103]
    v_cvt_pk_bf16_f32 v105, v88, v89
    v_cvt_pk_bf16_f32 v106, v90, v91
    v_mfma_f32_16x16x32_bf16 v[96:99], v[164:167], v[208:211], v[96:99]
    v_cvt_pk_bf16_f32 v107, v92, s18
    v_cvt_pk_bf16_f32 v111, v93, s18
    v_mfma_f32_16x16x32_bf16 v[100:103], v[164:167], v[212:215], v[100:103]
    v_cvt_pk_bf16_f32 v108, v94, v95
    v_mfma_f32_16x16x32_bf16 v[96:99], v[44:47], v[216:219], v[96:99]
    buffer_store_dwordx4 v[104:107], v12, s[56:59], s44 offen offset:2048 sc1
    v_mfma_f32_16x16x32_bf16 v[100:103], v[44:47], v[220:223], v[100:103]
    v_mfma_f32_16x16x32_bf16 v[72:75], a[112:115], v[192:195], 0
    s_nop 1
    v_mfma_f32_16x16x32_bf16 v[76:79], a[112:115], v[196:199], 0
    s_nop 0
    v_mfma_f32_16x16x32_bf16 v[72:75], v[128:131], v[200:203], v[72:75]
    v_mfma_f32_16x16x32_bf16 v[76:79], v[128:131], v[204:207], v[76:79]
    v_cvt_pk_bf16_f32 v109, v96, v97
    v_cvt_pk_bf16_f32 v110, v98, v99
    v_mfma_f32_16x16x32_bf16 v[72:75], v[168:171], v[208:211], v[72:75]
    v_cvt_pk_bf16_f32 v224, v100, v101
    v_cvt_pk_bf16_f32 v225, v102, v103
    v_mfma_f32_16x16x32_bf16 v[76:79], v[168:171], v[212:215], v[76:79]
    buffer_store_dwordx4 v[108:111], v12, s[56:59], s44 offen offset:3072 sc1
    v_mfma_f32_16x16x32_bf16 v[72:75], v[48:51], v[216:219], v[72:75]
    v_mfma_f32_16x16x32_bf16 v[76:79], v[48:51], v[220:223], v[76:79]
    v_mfma_f32_16x16x32_bf16 v[80:83], a[116:119], v[192:195], 0
    s_nop 1
    v_mfma_f32_16x16x32_bf16 v[84:87], a[116:119], v[196:199], 0
    s_nop 0
    v_mfma_f32_16x16x32_bf16 v[80:83], v[132:135], v[200:203], v[80:83]
    v_mfma_f32_16x16x32_bf16 v[84:87], v[132:135], v[204:207], v[84:87]
    v_cvt_pk_bf16_f32 v226, v72, v73
    v_cvt_pk_bf16_f32 v227, v74, s18
    v_mfma_f32_16x16x32_bf16 v[80:83], v[172:175], v[208:211], v[80:83]
    v_cvt_pk_bf16_f32 v231, v75, s18
    v_cvt_pk_bf16_f32 v228, v76, v77
    v_mfma_f32_16x16x32_bf16 v[84:87], v[172:175], v[212:215], v[84:87]
    v_cvt_pk_bf16_f32 v229, v78, v79
    v_mfma_f32_16x16x32_bf16 v[80:83], v[52:55], v[216:219], v[80:83]
    buffer_store_dwordx4 v[224:227], v12, s[56:59], s45 offen offset:0 sc1
    v_mfma_f32_16x16x32_bf16 v[84:87], v[52:55], v[220:223], v[84:87]
    v_mfma_f32_16x16x32_bf16 v[88:91], a[120:123], v[192:195], 0
    s_nop 1
    v_mfma_f32_16x16x32_bf16 v[92:95], a[120:123], v[196:199], 0
    s_nop 0
    v_mfma_f32_16x16x32_bf16 v[88:91], v[136:139], v[200:203], v[88:91]
    v_mfma_f32_16x16x32_bf16 v[92:95], v[136:139], v[204:207], v[92:95]
    v_cvt_pk_bf16_f32 v230, v80, v81
    v_cvt_pk_bf16_f32 v240, v82, v83
    v_mfma_f32_16x16x32_bf16 v[88:91], v[176:179], v[208:211], v[88:91]
    v_cvt_pk_bf16_f32 v241, v84, v85
    v_cvt_pk_bf16_f32 v242, v86, v87
    v_mfma_f32_16x16x32_bf16 v[92:95], v[176:179], v[212:215], v[92:95]
    buffer_store_dwordx4 v[228:231], v12, s[56:59], s45 offen offset:1024 sc1
    v_mfma_f32_16x16x32_bf16 v[88:91], v[56:59], v[216:219], v[88:91]
    buffer_store_dwordx4 v[240:243], v12, s[56:59], s45 offen offset:2048 sc1
    v_mfma_f32_16x16x32_bf16 v[92:95], v[56:59], v[220:223], v[92:95]
    v_mfma_f32_16x16x32_bf16 v[96:99], a[124:127], v[192:195], 0
    s_nop 1
    v_mfma_f32_16x16x32_bf16 v[100:103], a[124:127], v[196:199], 0
    s_nop 0
    v_mfma_f32_16x16x32_bf16 v[96:99], v[140:143], v[200:203], v[96:99]
    v_mfma_f32_16x16x32_bf16 v[100:103], v[140:143], v[204:207], v[100:103]
    v_cvt_pk_bf16_f32 v232, v88, v89
    v_cvt_pk_bf16_f32 v233, v90, v91
    v_mfma_f32_16x16x32_bf16 v[96:99], v[180:183], v[208:211], v[96:99]
    v_cvt_pk_bf16_f32 v234, v92, v93
    v_cvt_pk_bf16_f32 v235, v94, s18
    v_mfma_f32_16x16x32_bf16 v[100:103], v[180:183], v[212:215], v[100:103]
    v_cvt_pk_bf16_f32 v239, v95, s18
    v_mfma_f32_16x16x32_bf16 v[96:99], v[60:63], v[216:219], v[96:99]
    buffer_store_dwordx4 v[232:235], v12, s[56:59], s45 offen offset:3072 sc1
    v_mfma_f32_16x16x32_bf16 v[100:103], v[60:63], v[220:223], v[100:103]
    v_mfma_f32_16x16x32_bf16 v[72:75], a[128:131], v[192:195], 0
    s_nop 1
    v_mfma_f32_16x16x32_bf16 v[76:79], a[128:131], v[196:199], 0
    s_nop 0
    v_mfma_f32_16x16x32_bf16 v[72:75], v[144:147], v[200:203], v[72:75]
    v_mfma_f32_16x16x32_bf16 v[76:79], v[144:147], v[204:207], v[76:79]
    v_cvt_pk_bf16_f32 v236, v96, v97
    v_cvt_pk_bf16_f32 v237, v98, v99
    v_mfma_f32_16x16x32_bf16 v[72:75], v[184:187], v[208:211], v[72:75]
    v_cvt_pk_bf16_f32 v238, v100, v101
    v_cvt_pk_bf16_f32 v248, v102, v103
    v_mfma_f32_16x16x32_bf16 v[76:79], v[184:187], v[212:215], v[76:79]
    buffer_store_dwordx4 v[236:239], v12, s[56:59], s46 offen offset:0 sc1
    v_mfma_f32_16x16x32_bf16 v[72:75], v[64:67], v[216:219], v[72:75]
    v_mfma_f32_16x16x32_bf16 v[76:79], v[64:67], v[220:223], v[76:79]
    v_mfma_f32_16x16x32_bf16 v[80:83], a[132:135], v[192:195], 0
    s_nop 1
    v_mfma_f32_16x16x32_bf16 v[84:87], a[132:135], v[196:199], 0
    s_nop 0
    v_mfma_f32_16x16x32_bf16 v[80:83], v[148:151], v[200:203], v[80:83]
    v_mfma_f32_16x16x32_bf16 v[84:87], v[148:151], v[204:207], v[84:87]
    v_cvt_pk_bf16_f32 v249, v72, v73
    v_cvt_pk_bf16_f32 v250, v74, v75
    v_mfma_f32_16x16x32_bf16 v[80:83], v[188:191], v[208:211], v[80:83]
    v_cvt_pk_bf16_f32 v251, v76, s18
    v_cvt_pk_bf16_f32 v255, v77, s18
    v_mfma_f32_16x16x32_bf16 v[84:87], v[188:191], v[212:215], v[84:87]
    v_cvt_pk_bf16_f32 v252, v78, v79
    v_mfma_f32_16x16x32_bf16 v[80:83], v[68:71], v[216:219], v[80:83]
    buffer_store_dwordx4 v[248:251], v12, s[56:59], s46 offen offset:1024 sc1
    v_mfma_f32_16x16x32_bf16 v[84:87], v[68:71], v[220:223], v[84:87]
    s_nop 5
    v_cvt_pk_bf16_f32 v253, v80, v81
    v_cvt_pk_bf16_f32 v254, v82, v83
    buffer_store_dwordx4 v[252:255], v12, s[56:59], s46 offen offset:2048 sc1
    v_cvt_pk_bf16_f32 v244, v84, v85
    v_cvt_pk_bf16_f32 v245, v86, v87
    buffer_store_dwordx4 v[244:247], v12, s[56:59], s46 offen offset:3072 sc1
    v_lshrrev_b32 v8, 3, v1
    v_and_b32 v11, 0x70, v24
    v_lshl_or_b32 v11, v8, 10, v11
    s_and_b32 s29, s5, 15
    s_lshl_b32 s29, s29, 5
    s_add_u32 s29, s29, s3
    s_mul_i32 s29, s29, 12288
    s_add_u32 s29, s29, 2097152
    s_lshl_b32 s28, s4, 7
    s_add_u32 s28, s28, s29
    v_add_u32 v16, s8, v24
    v_and_b32 v9, 3, v1
    v_mul_u32_u24 v9, 96, v9
    v_and_b32 v21, 4, v1
    v_lshl_add_u32 v9, v21, 1, v9
    v_add_u32 v9, s8, v9
    v_lshrrev_b32 v10, 4, v1
    v_mul_u32_u24 v10, 7, v10
    v_and_b32 v8, 1, v8
    v_lshl_add_u32 v21, v8, 2, v10
    v_add_u32 v21, 0, v21
    v_and_b32 v22, 2, v21
    v_mul_u32_u24 v22, 188, v22
    v_lshl_add_u32 v22, v21, 2, v22
    v_add_u32 v2, v22, v9
    v_lshl_add_u32 v21, v8, 2, v10
    v_add_u32 v21, 1, v21
    v_and_b32 v22, 2, v21
    v_mul_u32_u24 v22, 188, v22
    v_lshl_add_u32 v22, v21, 2, v22
    v_add_u32 v3, v22, v9
    v_lshl_add_u32 v21, v8, 2, v10
    v_add_u32 v21, 2, v21
    v_and_b32 v22, 2, v21
    v_mul_u32_u24 v22, 188, v22
    v_lshl_add_u32 v22, v21, 2, v22
    v_add_u32 v4, v22, v9
    v_add_u32 v21, 3, v10
    v_and_b32 v22, 2, v21
    v_mul_u32_u24 v22, 188, v22
    v_lshl_add_u32 v22, v21, 2, v22
    v_add_u32 v5, v22, v9
    v_lshl_add_u32 v5, v8, 1, v5
    v_mul_u32_u24 v21, 10923, v1
    v_lshrrev_b32 v21, 16, v21
    v_lshrrev_b32 v22, 2, v21
    v_mul_u32_u24 v22, 15360, v22
    v_mul_u32_u24 v21, 1184, v21
    v_add3_u32 v17, v21, v22, v24
    s_lshr_b32 s13, s4, 1
    s_lshl_b32 s27, s7, 2
    s_add_u32 s27, s27, s3
    s_lshl_b32 s27, s27, 3
    s_add_u32 s27, s27, s13
    s_mul_i32 s27, s27, 5120
    s_and_b32 s14, s4, 1
    s_mul_i32 s14, s14, 160
    s_add_u32 s27, s27, s14
    s_mul_i32 s14, s6, 320
    s_add_u32 s27, s27, s14
    s_add_u32 s20, s28, 0
    s_add_u32 s21, s28, 49152
    s_add_u32 s22, s28, 98304
    s_add_u32 s23, s28, 147456
    s_add_u32 s24, s28, 196608
    s_add_u32 s25, s28, 245760
    s_add_u32 s26, s28, 294912
    s_add_u32 s31, s28, 344064
    s_mov_b32 s17, 20000
    s_mov_b32 exec_hi, 0xffffff
    s_waitcnt vmcnt(0)
L_rs0B:
    buffer_load_dwordx4 v[144:147], v11, s[56:59], s20 offen sc1
    buffer_load_dwordx4 v[148:151], v11, s[56:59], s21 offen sc1
    buffer_load_dwordx4 v[152:155], v11, s[56:59], s22 offen sc1
    buffer_load_dwordx4 v[156:159], v11, s[56:59], s23 offen sc1
    buffer_load_dwordx4 v[160:163], v11, s[56:59], s24 offen sc1
    buffer_load_dwordx4 v[164:167], v11, s[56:59], s25 offen sc1
    buffer_load_dwordx4 v[168:171], v11, s[56:59], s26 offen sc1
    buffer_load_dwordx4 v[172:175], v11, s[56:59], s31 offen sc1
    s_waitcnt vmcnt(7)
    v_lshlrev_b32 v176, 16, v144
    v_and_b32 v177, 0xffff0000, v144
    v_lshlrev_b32 v178, 16, v145
    v_and_b32 v179, 0xffff0000, v145
    v_lshlrev_b32 v180, 16, v146
    v_and_b32 v181, 0xffff0000, v146
    v_lshlrev_b32 v182, 16, v147
    s_waitcnt vmcnt(6)
    v_lshlrev_b32 v192, 16, v148
    v_and_b32 v193, 0xffff0000, v148
    v_lshlrev_b32 v194, 16, v149
    v_and_b32 v195, 0xffff0000, v149
    v_lshlrev_b32 v196, 16, v150
    v_and_b32 v197, 0xffff0000, v150
    v_lshlrev_b32 v198, 16, v151
    v_pk_add_f32 v[176:177], v[176:177], v[192:193]
    v_pk_add_f32 v[178:179], v[178:179], v[194:195]
    v_pk_add_f32 v[180:181], v[180:181], v[196:197]
    v_add_f32 v182, v182, v198
    v_min3_u32 v21, v147, v151, s16
    v_max3_u32 v22, v147, v151, s16
    s_waitcnt vmcnt(5)
    v_lshlrev_b32 v184, 16, v152
    v_and_b32 v185, 0xffff0000, v152
    v_lshlrev_b32 v186, 16, v153
    v_and_b32 v187, 0xffff0000, v153
    v_lshlrev_b32 v188, 16, v154
    v_and_b32 v189, 0xffff0000, v154
    v_lshlrev_b32 v190, 16, v155
    v_pk_add_f32 v[176:177], v[176:177], v[184:185]
    v_pk_add_f32 v[178:179], v[178:179], v[186:187]
    v_pk_add_f32 v[180:181], v[180:181], v[188:189]
    v_add_f32 v182, v182, v190
    s_waitcnt vmcnt(4)
    v_lshlrev_b32 v192, 16, v156
    v_and_b32 v193, 0xffff0000, v156
    v_lshlrev_b32 v194, 16, v157
    v_and_b32 v195, 0xffff0000, v157
    v_lshlrev_b32 v196, 16, v158
    v_and_b32 v197, 0xffff0000, v158
    v_lshlrev_b32 v198, 16, v159
    v_pk_add_f32 v[176:177], v[176:177], v[192:193]
    v_pk_add_f32 v[178:179], v[178:179], v[194:195]
    v_pk_add_f32 v[180:181], v[180:181], v[196:197]
    v_add_f32 v182, v182, v198
    v_min3_u32 v21, v21, v155, v159
    v_max3_u32 v22, v22, v155, v159
    s_waitcnt vmcnt(3)
    v_lshlrev_b32 v184, 16, v160
    v_and_b32 v185, 0xffff0000, v160
    v_lshlrev_b32 v186, 16, v161
    v_and_b32 v187, 0xffff0000, v161
    v_lshlrev_b32 v188, 16, v162
    v_and_b32 v189, 0xffff0000, v162
    v_lshlrev_b32 v190, 16, v163
    v_pk_add_f32 v[176:177], v[176:177], v[184:185]
    v_pk_add_f32 v[178:179], v[178:179], v[186:187]
    v_pk_add_f32 v[180:181], v[180:181], v[188:189]
    v_add_f32 v182, v182, v190
    s_waitcnt vmcnt(2)
    v_lshlrev_b32 v192, 16, v164
    v_and_b32 v193, 0xffff0000, v164
    v_lshlrev_b32 v194, 16, v165
    v_and_b32 v195, 0xffff0000, v165
    v_lshlrev_b32 v196, 16, v166
    v_and_b32 v197, 0xffff0000, v166
    v_lshlrev_b32 v198, 16, v167
    v_pk_add_f32 v[176:177], v[176:177], v[192:193]
    v_pk_add_f32 v[178:179], v[178:179], v[194:195]
    v_pk_add_f32 v[180:181], v[180:181], v[196:197]
    v_add_f32 v182, v182, v198
    v_min3_u32 v21, v21, v163, v167
    v_max3_u32 v22, v22, v163, v167
    s_waitcnt vmcnt(1)
    v_lshlrev_b32 v184, 16, v168
    v_and_b32 v185, 0xffff0000, v168
    v_lshlrev_b32 v186, 16, v169
    v_and_b32 v187, 0xffff0000, v169
    v_lshlrev_b32 v188, 16, v170
    v_and_b32 v189, 0xffff0000, v170
    v_lshlrev_b32 v190, 16, v171
    v_pk_add_f32 v[176:177], v[176:177], v[184:185]
    v_pk_add_f32 v[178:179], v[178:179], v[186:187]
    v_pk_add_f32 v[180:181], v[180:181], v[188:189]
    v_add_f32 v182, v182, v190
    s_waitcnt vmcnt(0)
    v_lshlrev_b32 v192, 16, v172
    v_and_b32 v193, 0xffff0000, v172
    v_lshlrev_b32 v194, 16, v173
    v_and_b32 v195, 0xffff0000, v173
    v_lshlrev_b32 v196, 16, v174
    v_and_b32 v197, 0xffff0000, v174
    v_lshlrev_b32 v198, 16, v175
    v_pk_add_f32 v[176:177], v[176:177], v[192:193]
    v_pk_add_f32 v[178:179], v[178:179], v[194:195]
    v_pk_add_f32 v[180:181], v[180:181], v[196:197]
    v_add_f32 v182, v182, v198
    v_min3_u32 v21, v21, v171, v175
    v_max3_u32 v22, v22, v171, v175
    v_xor_b32 v21, v21, v22
    v_cmp_lt_u32 vcc, 0xffff, v21
    v_cvt_pk_bf16_f32 v200, v176, v177
    v_cvt_pk_bf16_f32 v201, v178, v179
    v_cvt_pk_bf16_f32 v202, v180, v181
    v_cvt_pk_bf16_f32 v203, v182, v182
    s_cbranch_vccz L_rs1B
    s_sub_u32 s17, s17, 1
    s_cbranch_scc0 L_rs0B
L_rs1B:
    ds_write_b32 v2, v200
    ds_write_b32 v3, v201
    ds_write_b32 v4, v202
    s_mov_b32 exec_hi, 0xffff
    ds_write_b16 v5, v203
    ds_read_b128 v[204:207], v16
    s_waitcnt lgkmcnt(0)
    buffer_store_dwordx4 v[204:207], v17, s[52:55], s27 offen offset:0 sc1
L_end:
    s_endpgm
.section .rodata,"a"
.p2align 6
.amdhsa_kernel standalone__gqa_block_cached__near_ridge_kernel
  .amdhsa_next_free_vgpr 512
  .amdhsa_next_free_sgpr 102
  .amdhsa_accum_offset 256
  .amdhsa_group_segment_fixed_size 0
  .amdhsa_kernarg_size 64
  .amdhsa_user_sgpr_count 2
  .amdhsa_user_sgpr_kernarg_segment_ptr 1
  .amdhsa_system_sgpr_workgroup_id_x 1
.end_amdhsa_kernel
```
